```python
import torch

def _softmax(x, axis=-1):
    return torch.softmax(x, dim=axis)
def _gelu(x):
    return torch.nn.functional.gelu(x, approximate="tanh")
def _silu(x):
    return torch.nn.functional.silu(x)
def _sigmoid(x):
    return torch.sigmoid(x)
def _layernorm(x, axis=-1, eps=1e-5):
    m = x.mean(dim=axis, keepdim=True)
    v = x.var(dim=axis, keepdim=True, unbiased=False)
    return (x - m) / torch.sqrt(v + eps)
def _scatter_add(tgt, idx, src, axis=0):
    return tgt.clone().index_add_(axis, idx, src)
def _segment_sum(src, seg, n):
    out = torch.zeros((n,) + src.shape[1:], dtype=src.dtype)
    return out.index_add_(0, seg, src)
def _pad(x, pw):
    flat = tuple(v for pair in reversed(pw) for v in pair)
    return torch.nn.functional.pad(x, flat)

kernel_name = 'standalone__dense_activation_silu__prompt'

def setup_inputs():

    _w = (lambda a: (lambda t: t.to(torch.bfloat16) if t.is_floating_point() else t)(torch.as_tensor(a)))
    B, S, D, F = 1, 2048, 640, 1536
    return {
        "x": _w((lambda *s: torch.randn(*s, dtype=torch.bfloat16) * 0.1)(B, S, D)),
        "w1": _w((lambda *s: torch.randn(*s, dtype=torch.bfloat16) * 3.2)(D, F) * (D ** -0.5)),
        "w2": _w((lambda *s: torch.randn(*s, dtype=torch.bfloat16) * 3.2)(F, D) * (F ** -0.5)),
    }

def reference(x, w1, w2):
    h = torch.einsum("bsd,df->bsf", x, w1)
    h = _silu(h)
    out = torch.einsum("bsf,fd->bsd", h, w2)
    return out
```

```asm
; @launch grid=(256,1,1) block=(256,1,1) lds=163840
.amdgcn_target "amdgcn-amd-amdhsa--gfx950"
.text
.globl standalone__dense_activation_silu__prompt_kernel
.p2align 8
.type standalone__dense_activation_silu__prompt_kernel,@function
standalone__dense_activation_silu__prompt_kernel:
    s_cmp_ge_u32 s2, 256
    s_cbranch_scc1 L_end
    s_load_dwordx8 s[4:11], s[0:1], 0
    s_load_dwordx2 s[12:13], s[0:1], 40
    v_and_b32 v46, 63, v0
    v_lshrrev_b32 v47, 6, v0
    v_lshlrev_b32 v1, 4, v46
    v_readfirstlane_b32 s36, v47
    s_getpc_b64 s[14:15]
L_pc:
    s_lshr_b32 s45, s2, 3
    s_and_b32 s45, s45, 3
    s_lshl_b32 s45, s45, 12
    v_lshl_add_u32 v48, v0, 4, s45
    v_min_u32 v48, L_end-L_pc-16, v48
    global_load_dwordx4 v[252:255], v48, s[14:15]
    s_and_b32 s45, s2, 7
    s_lshr_b32 s46, s2, 3
    s_and_b32 s38, s46, 3
    s_lshr_b32 s37, s46, 2
    s_lshr_b32 s39, s37, 0
    s_mul_i32 s39, s39, 10
    s_lshr_b32 s46, s38, 0
    s_mul_i32 s46, s46, 10
    s_add_u32 s39, s39, s46
    s_lshr_b32 s39, s39, 2
    s_mul_i32 s46, s39, 205
    s_lshr_b32 s46, s46, 11
    s_mul_i32 s46, s46, 10
    s_sub_u32 s39, s39, s46
    s_mul_i32 s55, s37, 12
    s_lshr_b32 s55, s55, 3
    s_and_b32 s46, s45, 1
    s_lshl_b32 s46, s46, 2
    s_add_u32 s38, s38, s46
    s_lshr_b32 s46, s45, 1
    s_lshl_b32 s46, s46, 3
    s_add_u32 s37, s37, s46
    s_mul_i32 s41, s37, 81920
    s_mul_i32 s42, s38, 384
    s_add_u32 s43, s41, 1280
    s_mul_i32 s40, s39, 196608
    s_add_u32 s40, s40, s42
    s_lshl_b32 s39, s39, 7
    s_add_u32 s39, s39, s41
    v_lshrrev_b32 v52, 4, v46
    v_lshrrev_b32 v48, 3, v46
    v_lshl_add_u32 v48, v47, 4, v48
    v_mul_u32_u24 v48, 1280, v48
    v_and_b32 v49, 7, v46
    v_xor_b32 v49, v49, v52
    v_lshl_add_u32 v24, v49, 4, v48
    v_xor_b32 v49, 4, v49
    v_lshl_add_u32 v25, v49, 4, v48
    v_add_u32 v25, 9216, v25
    v_mul_u32_u24 v51, 49152, v47
    v_mul_u32_u24 v49, 2731, v46
    v_lshrrev_b32 v49, 16, v49
    v_mul_u32_u24 v50, 24, v49
    v_sub_u32 v48, v46, v50
    v_and_b32 v50, 2, v49
    v_lshlrev_b32 v50, 1, v50
    v_xor_b32 v48, v48, v50
    v_mul_u32_u24 v49, 3072, v49
    v_lshl_add_u32 v48, v48, 4, v49
    v_add_u32 v48, v48, v51
    v_mov_b32 v26, v48
    v_xor_b32 v48, 16, v48
    v_add_u32 v29, 21504, v48
    v_add_u32 v48, 64, v46
    v_mul_u32_u24 v49, 2731, v48
    v_lshrrev_b32 v49, 16, v49
    v_mul_u32_u24 v50, 24, v49
    v_sub_u32 v48, v48, v50
    v_and_b32 v50, 2, v49
    v_lshlrev_b32 v50, 1, v50
    v_xor_b32 v48, v48, v50
    v_mul_u32_u24 v49, 3072, v49
    v_lshl_add_u32 v48, v48, 4, v49
    v_add_u32 v48, v48, v51
    v_subrev_u32 v27, 1024, v48
    v_xor_b32 v48, 16, v48
    v_add_u32 v30, 24576, v48
    v_add_u32 v48, 128, v46
    v_mul_u32_u24 v49, 2731, v48
    v_lshrrev_b32 v49, 16, v49
    v_mul_u32_u24 v50, 24, v49
    v_sub_u32 v48, v48, v50
    v_and_b32 v50, 2, v49
    v_lshlrev_b32 v50, 1, v50
    v_xor_b32 v48, v48, v50
    v_mul_u32_u24 v49, 3072, v49
    v_lshl_add_u32 v48, v48, 4, v49
    v_add_u32 v48, v48, v51
    v_subrev_u32 v28, 2048, v48
    v_xor_b32 v48, 16, v48
    v_add_u32 v31, 23552, v48
    s_lshl_b32 s44, s36, 13
    s_mov_b32 s15, 6324224
    s_mov_b32 s18, 2621440
    s_mov_b32 s19, 0x20000
    s_mov_b32 s22, 1966080
    s_mov_b32 s23, 0x20000
    s_mov_b32 s26, 1966080
    s_mov_b32 s27, 0x20000
    s_mov_b32 s30, 2621440
    s_mov_b32 s31, 0x20000
    s_mov_b32 s34, 8388608
    s_mov_b32 s35, 0x20000
    s_waitcnt lgkmcnt(0)
    s_mov_b64 s[24:25], s[8:9]
    s_mov_b64 s[16:17], s[4:5]
    s_mov_b64 s[20:21], s[6:7]
    s_mov_b64 s[28:29], s[10:11]
    s_mov_b64 s[32:33], s[12:13]
    s_load_dword s47, s[12:13], s15
    s_add_u32 m0, s44, 6144
    s_nop 0
    buffer_load_dwordx4 v24, s[16:19], s39 offen offset:0  lds
    buffer_load_dwordx4 v25, s[16:19], s39 offen offset:1024  lds
    s_add_u32 m0, s44, 0
    s_nop 0
    buffer_load_dwordx4 v26, s[20:23], s40 offen offset:0  lds
    buffer_load_dwordx4 v27, s[20:23], s40 offen offset:1024  lds
    s_lshr_b32 s46, s2, 1
    s_and_b32 s45, s2, 1
    s_mul_i32 s14, s46, 43
    s_lshr_b32 s14, s14, 9
    s_mul_i32 s14, s14, 4
    s_add_u32 s14, s14, s46
    s_mul_i32 s14, s14, 8
    s_lshl_b32 s56, s45, 9
    s_add_u32 s14, s14, s56
    s_lshl_b32 s56, s46, 2
    s_add_u32 s56, s56, s36
    s_mul_i32 s56, s56, 10240
    s_lshl_b32 s45, s45, 7
    s_add_u32 s56, s56, s45
    s_add_u32 s56, s56, 1024
    s_lshl_b32 s57, s2, 2
    s_add_u32 s57, s57, s36
    s_lshl_b32 s57, s57, 10
    s_add_u32 s57, s57, 6422528
    s_cmp_lt_u32 s2, 96
    s_cselect_b32 s56, s56, 1966080
    s_cselect_b32 s57, s57, 8388608
    s_cselect_b32 s14, s14, 2031616
    v_lshrrev_b32 v48, 3, v46
    v_mul_u32_u24 v48, 1280, v48
    v_and_b32 v49, 7, v46
    v_lshlrev_b32 v50, 1, v52
    v_xor_b32 v49, v49, v50
    v_lshl_add_u32 v56, v49, 4, v48
    v_add_u32 v57, 9216, v56
    v_add_u32 v58, 18432, v56
    v_add_u32 v59, 27648, v56
    v_bfe_u32 v48, v46, 2, 2
    v_and_b32 v49, 3, v46
    v_and_b32 v54, 1, v52
    v_lshl_add_u32 v53, v54, 3, v48
    v_mul_u32_u24 v53, 384, v53
    v_lshl_add_u32 v53, v54, 4, v53
    v_lshrrev_b32 v50, 5, v46
    v_lshl_add_u32 v53, v50, 13, v53
    v_lshrrev_b32 v54, 1, v48
    v_xor_b32 v54, v54, v47
    v_and_b32 v54, 1, v54
    v_lshl_add_u32 v53, v54, 6, v53
    v_lshrrev_b32 v54, 1, v49
    v_lshl_add_u32 v53, v54, 5, v53
    v_and_b32 v54, 1, v49
    v_lshl_add_u32 v34, v54, 3, v53
    v_xor_b32 v35, 16, v34
    v_add_u32 v36, 65536, v34
    v_add_u32 v37, 65536, v35
    v_and_b32 v53, 2, v47
    v_lshlrev_b32 v53, 13, v53
    v_and_b32 v55, 15, v46
    v_lshl_add_u32 v53, v55, 7, v53
    v_add_u32 v53, 6144, v53
    v_lshrrev_b32 v54, 1, v55
    v_xor_b32 v54, v54, v52
    v_lshl_add_u32 v40, v54, 4, v53
    v_xor_b32 v41, 64, v40
    v_add_u32 v42, 65536, v40
    v_add_u32 v43, 65536, v41
    v_and_b32 v54, 1, v52
    v_lshl_add_u32 v54, v54, 2, v48
    v_lshlrev_b32 v53, 11, v50
    v_lshl_add_u32 v53, v54, 7, v53
    v_lshrrev_b32 v54, 1, v54
    v_lshl_add_u32 v53, v54, 5, v53
    v_and_b32 v54, 1, v49
    v_lshl_add_u32 v53, v54, 4, v53
    v_lshrrev_b32 v54, 1, v49
    v_lshl_add_u32 v53, v54, 3, v53
    v_add_u32 v53, 98304, v53
    v_lshlrev_b32 v51, 5, v47
    v_xor_b32 v44, v53, v51
    v_add_u32 v60, s44, v53
    v_xor_b32 v61, 32, v60
    v_xor_b32 v62, 64, v60
    v_xor_b32 v63, 96, v60
    v_mov_b32 v64, 0
    v_mov_b32 v65, 0
    v_mov_b32 v66, 0
    v_mov_b32 v67, 0
    v_mov_b32 v68, 0
    v_mov_b32 v69, 0
    v_mov_b32 v70, 0
    v_mov_b32 v71, 0
    v_mov_b32 v72, 0
    v_mov_b32 v73, 0
    v_mov_b32 v74, 0
    v_mov_b32 v75, 0
    v_mov_b32 v76, 0
    v_mov_b32 v77, 0
    v_mov_b32 v78, 0
    v_mov_b32 v79, 0
    v_mov_b32 v80, 0
    v_mov_b32 v81, 0
    v_mov_b32 v82, 0
    v_mov_b32 v83, 0
    v_mov_b32 v84, 0
    v_mov_b32 v85, 0
    v_mov_b32 v86, 0
    v_mov_b32 v87, 0
    v_mov_b32 v88, 0
    v_mov_b32 v89, 0
    v_mov_b32 v90, 0
    v_mov_b32 v91, 0
    v_mov_b32 v92, 0
    v_mov_b32 v93, 0
    v_mov_b32 v94, 0
    v_mov_b32 v95, 0
    v_mov_b32 v96, 0
    v_mov_b32 v97, 0
    v_mov_b32 v98, 0
    v_mov_b32 v99, 0
    v_mov_b32 v100, 0
    v_mov_b32 v101, 0
    v_mov_b32 v102, 0
    v_mov_b32 v103, 0
    v_mov_b32 v104, 0
    v_mov_b32 v105, 0
    v_mov_b32 v106, 0
    v_mov_b32 v107, 0
    v_mov_b32 v108, 0
    v_mov_b32 v109, 0
    v_mov_b32 v110, 0
    v_mov_b32 v111, 0
    v_and_b32 v54, 1, v52
    v_add_u32 v7, 12288, v1
    v_mul_u32_u24 v53, 1280, v55
    v_lshl_add_u32 v3, v52, 4, v53
    v_lshl_add_u32 v53, v54, 4, v53
    v_lshl_add_u32 v4, v50, 3, v53
    v_lshrrev_b32 v2, 2, v46
    v_mul_u32_u24 v53, 1280, v2
    v_lshl_add_u32 v3, v49, 4, v53
    v_lshl_add_u32 v2, v49, 4, v2
    v_lshlrev_b32 v2, 2, v2
    buffer_load_dwordx4 v28, s[20:23], s40 offen offset:2048  lds
    v_and_b32 v4, 1, v49
    v_lshl_add_u32 v53, v4, 4, v53
    v_lshrrev_b32 v4, 1, v49
    v_lshl_add_u32 v4, v4, 3, v53
    v_mul_u32_u24 v53, 5120, v52
    v_lshl_add_u32 v53, v49, 1, v53
    v_and_b32 v4, 1, v48
    v_lshl_add_u32 v53, v4, 4, v53
    v_lshrrev_b32 v4, 1, v48
    v_lshl_add_u32 v4, v4, 3, v53
    s_lshr_b32 s45, s38, 2
    s_lshl_b32 s45, s45, 2
    buffer_load_dwordx4 v29, s[20:23], s40 offen offset:3072  lds
    s_add_u32 m0, s44, 4096
    s_nop 0
    s_add_u32 s45, s45, s36
    s_mul_i32 s45, s45, 128
    v_min_u32 v6, 11, v55
    v_lshl_add_u32 v6, v6, 3, s45
    v_lshlrev_b32 v9, 2, v46
    v_mul_u32_u24 v19, 128, v54
    v_lshlrev_b32 v23, 7, v0
    s_add_u32 s45, s44, 32768
    v_add_u32 v5, s45, v1
    v_add_u32 v20, 65536, v5
    s_sub_u32 s45, s36, 1
    s_and_b32 s45, s45, 3
    buffer_load_dwordx4 v30, s[20:23], s40 offen offset:0  lds
    s_lshl_b32 s45, s45, 13
    s_add_u32 s45, s45, 32768
    v_add_u32 v10, s45, v1
    s_sub_u32 s45, s36, 2
    s_and_b32 s45, s45, 3
    s_lshl_b32 s45, s45, 13
    s_add_u32 s45, s45, 65536
    v_add_u32 v11, s45, v1
    s_sub_u32 s45, s36, 3
    s_and_b32 s45, s45, 3
    s_lshl_b32 s45, s45, 13
    s_add_u32 s45, s45, 98304
    buffer_load_dwordx4 v31, s[20:23], s40 offen offset:1024  lds
    s_add_u32 s39, s39, 128
    s_add_u32 s40, s40, 196608
    s_cmp_eq_u32 s39, s43
    s_cselect_b32 s39, s41, s39
    s_cselect_b32 s40, s42, s40
    v_add_u32 v12, s45, v1
    s_mul_i32 s53, s36, 491520
    s_lshl_b32 s45, s38, 7
    s_add_u32 s53, s53, s45
    s_mul_i32 s6, s36, 96
    s_add_u32 s6, s6, s38
    s_lshl_b32 s6, s6, 10
    s_add_u32 s6, s6, 6422528
    s_lshl_b32 s60, s55, 10
    s_add_u32 s55, s55, 1
    s_cmp_ge_u32 s55, 12
    s_cselect_b32 s55, 0, s55
    s_lshl_b32 s61, s55, 10
    s_add_u32 m0, s44, 38912
    s_nop 0
    buffer_load_dwordx4 v24, s[16:19], s39 offen offset:0  lds
    s_add_u32 s55, s55, 1
    s_cmp_ge_u32 s55, 12
    s_cselect_b32 s55, 0, s55
    s_lshl_b32 s62, s55, 10
    s_add_u32 s55, s55, 1
    s_cmp_ge_u32 s55, 12
    s_cselect_b32 s55, 0, s55
    s_lshl_b32 s63, s55, 10
    s_add_u32 s55, s55, 1
    s_cmp_ge_u32 s55, 12
    s_cselect_b32 s55, 0, s55
    s_lshl_b32 s64, s55, 10
    s_add_u32 s55, s55, 1
    s_cmp_ge_u32 s55, 12
    s_cselect_b32 s55, 0, s55
    s_lshl_b32 s65, s55, 10
    buffer_load_dwordx4 v25, s[16:19], s39 offen offset:1024  lds
    s_add_u32 m0, s44, 32768
    s_nop 0
    s_add_u32 s55, s55, 1
    s_cmp_ge_u32 s55, 12
    s_cselect_b32 s55, 0, s55
    s_lshl_b32 s66, s55, 10
    s_add_u32 s55, s55, 1
    s_cmp_ge_u32 s55, 12
    s_cselect_b32 s55, 0, s55
    s_lshl_b32 s67, s55, 10
    s_add_u32 s55, s55, 1
    s_cmp_ge_u32 s55, 12
    s_cselect_b32 s55, 0, s55
    s_lshl_b32 s68, s55, 10
    s_add_u32 s55, s55, 1
    s_cmp_ge_u32 s55, 12
    s_cselect_b32 s55, 0, s55
    s_lshl_b32 s69, s55, 10
    buffer_load_dwordx4 v26, s[20:23], s40 offen offset:0  lds
    s_add_u32 s55, s55, 1
    s_cmp_ge_u32 s55, 12
    s_cselect_b32 s55, 0, s55
    s_lshl_b32 s70, s55, 10
    s_add_u32 s55, s55, 1
    s_cmp_ge_u32 s55, 12
    s_cselect_b32 s55, 0, s55
    s_lshl_b32 s71, s55, 10
    s_mov_b32 s54, s36
    s_and_b32 s54, s54, 3
    s_lshl_b32 s46, s37, 2
    s_add_u32 s46, s46, s36
    s_mul_i32 s52, s46, 256
    s_add_u32 s52, s52, 6291456
    buffer_load_dwordx4 v27, s[20:23], s40 offen offset:1024  lds
    s_lshl_b32 s46, s46, 2
    s_add_u32 s45, s54, 1
    s_and_b32 s45, s45, 3
    s_add_u32 s45, s45, s46
    s_mul_i32 s45, s45, 12288
    v_add_u32 v13, s45, v1
    s_add_u32 s45, s54, 2
    s_and_b32 s45, s45, 3
    s_add_u32 s45, s45, s46
    s_mul_i32 s45, s45, 12288
    v_add_u32 v14, s45, v1
    s_add_u32 s45, s54, 3
    buffer_load_dwordx4 v28, s[20:23], s40 offen offset:2048  lds
    s_and_b32 s45, s45, 3
    s_add_u32 s45, s45, s46
    s_mul_i32 s45, s45, 12288
    v_add_u32 v15, s45, v1
    s_add_u32 s45, s54, 4
    s_and_b32 s45, s45, 3
    s_add_u32 s45, s45, s46
    s_mul_i32 s45, s45, 12288
    v_add_u32 v16, s45, v1
    s_lshl_b32 s3, s37, 2
    s_add_u32 s3, s3, s54
    s_mul_i32 s3, s3, 20480
    buffer_load_dwordx4 v29, s[20:23], s40 offen offset:3072  lds
    s_add_u32 m0, s44, 36864
    s_nop 0
    s_lshl_b32 s45, s38, 5
    s_add_u32 s7, s3, s45
    s_add_u32 s7, s7, 896
    s_mul_i32 s45, s38, 128
    s_add_u32 s3, s3, s45
    s_lshl_b32 s45, s37, 2
    s_lshr_b32 s46, s38, 1
    s_add_u32 s45, s45, s46
    s_mul_i32 s51, s45, 256
    s_lshl_b32 s45, s45, 2
    s_and_b32 s46, s36, 2
    s_add_u32 s45, s45, s46
    buffer_load_dwordx4 v30, s[20:23], s40 offen offset:0  lds
    s_mul_i32 s49, s45, 12288
    s_and_b32 s45, s38, 1
    s_mul_i32 s46, s45, 128
    s_add_u32 s51, s51, s46
    s_add_u32 s51, s51, 6291456
    s_mul_i32 s45, s45, 6
    s_and_b32 s46, s36, 1
    s_add_u32 s45, s45, s46
    s_lshl_b32 s45, s45, 10
    s_add_u32 s49, s49, s45
    s_add_u32 s50, s49, 4096
    s_add_u32 s14, s14, 6356992
    buffer_load_dwordx4 v31, s[20:23], s40 offen offset:1024  lds
    s_add_u32 s39, s39, 128
    s_add_u32 s40, s40, 196608
    s_cmp_eq_u32 s39, s43
    s_cselect_b32 s39, s41, s39
    s_cselect_b32 s40, s42, s40
    s_cmp_eq_u32 s36, 0
    s_cselect_b32 s14, s14, 8388608
    s_mov_b32 s59, 0xbfb8aa3b
    s_mov_b32 s4, 0xbfb8aa3b
    s_mov_b32 s5, 0xbfb8aa3b
    s_waitcnt vmcnt(8)
    s_waitcnt lgkmcnt(0)
    s_barrier
    ds_read_b128 v[160:163], v40 offset:0
    ds_read_b64_tr_b16 v[112:113], v34 offset:0
    ds_read_b64_tr_b16 v[114:115], v34 offset:1536
    ds_read_b128 v[164:167], v40 offset:8192
    s_lshr_b32 m0, s44, 3
    s_add_u32 m0, m0, 98304
    s_nop 0
    buffer_load_dwordx4 v56, s[24:27], s56 offen nt lds
    ds_read_b64_tr_b16 v[116:117], v35 offset:0
    ds_read_b64_tr_b16 v[118:119], v35 offset:1536
    s_add_u32 m0, s44, 71680
    s_nop 0
    buffer_load_dwordx4 v24, s[16:19], s39 offen offset:0  lds
    ds_read_b64_tr_b16 v[120:121], v34 offset:128
    ds_read_b64_tr_b16 v[122:123], v34 offset:1664
    buffer_load_dwordx4 v25, s[16:19], s39 offen offset:1024  lds
    s_add_u32 m0, s44, 65536
    s_nop 0
    ds_read_b64_tr_b16 v[124:125], v35 offset:128
    ds_read_b64_tr_b16 v[126:127], v35 offset:1664
    buffer_load_dwordx4 v26, s[20:23], s40 offen offset:0  lds
    ds_read_b64_tr_b16 v[128:129], v34 offset:256
    ds_read_b64_tr_b16 v[130:131], v34 offset:1792
    buffer_load_dwordx4 v27, s[20:23], s40 offen offset:1024  lds
    ds_read_b64_tr_b16 v[132:133], v35 offset:256
    ds_read_b64_tr_b16 v[134:135], v35 offset:1792
    s_waitcnt lgkmcnt(11)
    v_mfma_f32_16x16x32_bf16 v[64:67], v[112:115], v[160:163], v[64:67]
    ds_read_b128 v[168:171], v41 offset:0
    ds_read_b64_tr_b16 v[136:137], v34 offset:16384
    s_waitcnt lgkmcnt(12)
    v_mfma_f32_16x16x32_bf16 v[72:75], v[112:115], v[164:167], v[72:75]
    ds_read_b64_tr_b16 v[138:139], v34 offset:17920
    ds_read_b128 v[172:175], v41 offset:8192
    s_waitcnt lgkmcnt(12)
    v_mfma_f32_16x16x32_bf16 v[68:71], v[116:119], v[160:163], v[68:71]
    buffer_load_dwordx4 v28, s[20:23], s40 offen offset:2048  lds
    v_mfma_f32_16x16x32_bf16 v[76:79], v[116:119], v[164:167], v[76:79]
    ds_read_b64_tr_b16 v[140:141], v35 offset:16384
    ds_read_b64_tr_b16 v[142:143], v35 offset:17920
    s_waitcnt lgkmcnt(12)
    v_mfma_f32_16x16x32_bf16 v[80:83], v[120:123], v[160:163], v[80:83]
    ds_read_b64_tr_b16 v[144:145], v34 offset:16512
    ds_read_b64_tr_b16 v[146:147], v34 offset:18048
    v_mfma_f32_16x16x32_bf16 v[88:91], v[120:123], v[164:167], v[88:91]
    buffer_load_dwordx4 v29, s[20:23], s40 offen offset:3072  lds
    s_add_u32 m0, s44, 69632
    s_nop 0
    s_waitcnt lgkmcnt(12)
    v_mfma_f32_16x16x32_bf16 v[84:87], v[124:127], v[160:163], v[84:87]
    ds_read_b64_tr_b16 v[148:149], v35 offset:16512
    ds_read_b64_tr_b16 v[150:151], v35 offset:18048
    v_mfma_f32_16x16x32_bf16 v[92:95], v[124:127], v[164:167], v[92:95]
    ds_read_b64_tr_b16 v[152:153], v34 offset:16640
    ds_read_b64_tr_b16 v[154:155], v34 offset:18176
    s_waitcnt lgkmcnt(14)
    v_mfma_f32_16x16x32_bf16 v[96:99], v[128:131], v[160:163], v[96:99]
    buffer_load_dwordx4 v30, s[20:23], s40 offen offset:0  lds
    v_mfma_f32_16x16x32_bf16 v[104:107], v[128:131], v[164:167], v[104:107]
    ds_read_b64_tr_b16 v[156:157], v35 offset:16640
    ds_read_b64_tr_b16 v[158:159], v35 offset:18176
    s_waitcnt lgkmcnt(14)
    v_mfma_f32_16x16x32_bf16 v[100:103], v[132:135], v[160:163], v[100:103]
    v_mfma_f32_16x16x32_bf16 v[108:111], v[132:135], v[164:167], v[108:111]
    buffer_load_dwordx4 v31, s[20:23], s40 offen offset:1024  lds
    s_add_u32 s39, s39, 128
    s_add_u32 s40, s40, 196608
    s_cmp_eq_u32 s39, s43
    s_cselect_b32 s39, s41, s39
    s_cselect_b32 s40, s42, s40
    s_mov_b64 exec, 0
    s_cmp_eq_u32 s36, 1
    s_cbranch_scc1 L_w1
    s_cmp_eq_u32 s36, 2
    s_cbranch_scc1 L_w2
    s_cmp_eq_u32 s36, 3
    s_cbranch_scc1 L_w3
L_wr:
    s_mov_b64 exec, -1
    s_waitcnt vmcnt(9)
    s_waitcnt lgkmcnt(0)
    s_barrier
    v_mfma_f32_16x16x32_bf16 v[64:67], v[136:139], v[168:171], v[64:67]
    ds_read_b128 v[160:163], v40 offset:32768
    ds_read_b64_tr_b16 v[112:113], v34 offset:32768
    v_mfma_f32_16x16x32_bf16 v[72:75], v[136:139], v[172:175], v[72:75]
    ds_read_b64_tr_b16 v[114:115], v34 offset:34304
    ds_read_b128 v[164:167], v40 offset:40960
    v_mfma_f32_16x16x32_bf16 v[68:71], v[140:143], v[168:171], v[68:71]
    s_add_u32 m0, s44, 6144
    s_nop 0
    buffer_load_dwordx4 v24, s[16:19], s39 offen offset:0  lds
    v_mfma_f32_16x16x32_bf16 v[76:79], v[140:143], v[172:175], v[76:79]
    ds_read_b64_tr_b16 v[116:117], v35 offset:32768
    ds_read_b64_tr_b16 v[118:119], v35 offset:34304
    v_mfma_f32_16x16x32_bf16 v[80:83], v[144:147], v[168:171], v[80:83]
    ds_read_b64_tr_b16 v[120:121], v34 offset:32896
    ds_read_b64_tr_b16 v[122:123], v34 offset:34432
    v_mfma_f32_16x16x32_bf16 v[88:91], v[144:147], v[172:175], v[88:91]
    buffer_load_dwordx4 v25, s[16:19], s39 offen offset:1024  lds
    s_add_u32 m0, s44, 0
    s_nop 0
    v_mfma_f32_16x16x32_bf16 v[84:87], v[148:151], v[168:171], v[84:87]
    ds_read_b64_tr_b16 v[124:125], v35 offset:32896
    ds_read_b64_tr_b16 v[126:127], v35 offset:34432
    v_mfma_f32_16x16x32_bf16 v[92:95], v[148:151], v[172:175], v[92:95]
    ds_read_b64_tr_b16 v[128:129], v34 offset:33024
    ds_read_b64_tr_b16 v[130:131], v34 offset:34560
    v_mfma_f32_16x16x32_bf16 v[96:99], v[152:155], v[168:171], v[96:99]
    buffer_load_dwordx4 v26, s[20:23], s40 offen offset:0  lds
    v_mfma_f32_16x16x32_bf16 v[104:107], v[152:155], v[172:175], v[104:107]
    ds_read_b64_tr_b16 v[132:133], v35 offset:33024
    ds_read_b64_tr_b16 v[134:135], v35 offset:34560
    v_mfma_f32_16x16x32_bf16 v[100:103], v[156:159], v[168:171], v[100:103]
    v_mfma_f32_16x16x32_bf16 v[108:111], v[156:159], v[172:175], v[108:111]
    buffer_load_dwordx4 v27, s[20:23], s40 offen offset:1024  lds
    s_waitcnt lgkmcnt(11)
    v_mfma_f32_16x16x32_bf16 v[64:67], v[112:115], v[160:163], v[64:67]
    ds_read_b128 v[168:171], v41 offset:32768
    ds_read_b64_tr_b16 v[136:137], v34 offset:49152
    s_waitcnt lgkmcnt(12)
    v_mfma_f32_16x16x32_bf16 v[72:75], v[112:115], v[164:167], v[72:75]
    ds_read_b64_tr_b16 v[138:139], v34 offset:50688
    ds_read_b128 v[172:175], v41 offset:40960
    s_waitcnt lgkmcnt(12)
    v_mfma_f32_16x16x32_bf16 v[68:71], v[116:119], v[160:163], v[68:71]
    buffer_load_dwordx4 v28, s[20:23], s40 offen offset:2048  lds
    v_mfma_f32_16x16x32_bf16 v[76:79], v[116:119], v[164:167], v[76:79]
    ds_read_b64_tr_b16 v[140:141], v35 offset:49152
    ds_read_b64_tr_b16 v[142:143], v35 offset:50688
    s_waitcnt lgkmcnt(12)
    v_mfma_f32_16x16x32_bf16 v[80:83], v[120:123], v[160:163], v[80:83]
    ds_read_b64_tr_b16 v[144:145], v34 offset:49280
    ds_read_b64_tr_b16 v[146:147], v34 offset:50816
    v_mfma_f32_16x16x32_bf16 v[88:91], v[120:123], v[164:167], v[88:91]
    buffer_load_dwordx4 v29, s[20:23], s40 offen offset:3072  lds
    s_add_u32 m0, s44, 4096
    s_nop 0
    s_waitcnt lgkmcnt(12)
    v_mfma_f32_16x16x32_bf16 v[84:87], v[124:127], v[160:163], v[84:87]
    ds_read_b64_tr_b16 v[148:149], v35 offset:49280
    ds_read_b64_tr_b16 v[150:151], v35 offset:50816
    v_mfma_f32_16x16x32_bf16 v[92:95], v[124:127], v[164:167], v[92:95]
    ds_read_b64_tr_b16 v[152:153], v34 offset:49408
    ds_read_b64_tr_b16 v[154:155], v34 offset:50944
    s_waitcnt lgkmcnt(14)
    v_mfma_f32_16x16x32_bf16 v[96:99], v[128:131], v[160:163], v[96:99]
    buffer_load_dwordx4 v30, s[20:23], s40 offen offset:0  lds
    v_mfma_f32_16x16x32_bf16 v[104:107], v[128:131], v[164:167], v[104:107]
    ds_read_b64_tr_b16 v[156:157], v35 offset:49408
    ds_read_b64_tr_b16 v[158:159], v35 offset:50944
    s_waitcnt lgkmcnt(14)
    v_mfma_f32_16x16x32_bf16 v[100:103], v[132:135], v[160:163], v[100:103]
    v_mfma_f32_16x16x32_bf16 v[108:111], v[132:135], v[164:167], v[108:111]
    buffer_load_dwordx4 v31, s[20:23], s40 offen offset:1024  lds
    s_add_u32 s39, s39, 128
    s_add_u32 s40, s40, 196608
    s_cmp_eq_u32 s39, s43
    s_cselect_b32 s39, s41, s39
    s_cselect_b32 s40, s42, s40
    s_waitcnt vmcnt(8)
    s_waitcnt lgkmcnt(0)
    s_barrier
    v_mfma_f32_16x16x32_bf16 v[64:67], v[136:139], v[168:171], v[64:67]
    ds_read_b128 v[160:163], v42 offset:0
    ds_read_b64_tr_b16 v[112:113], v36 offset:0
    v_mfma_f32_16x16x32_bf16 v[72:75], v[136:139], v[172:175], v[72:75]
    ds_read_b64_tr_b16 v[114:115], v36 offset:1536
    ds_read_b128 v[164:167], v42 offset:8192
    v_mfma_f32_16x16x32_bf16 v[68:71], v[140:143], v[168:171], v[68:71]
    ds_read_b64_tr_b16 v[192:193], v44 offset:0
    ds_read_b64_tr_b16 v[194:195], v44 offset:1024
    s_add_u32 m0, s44, 38912
    s_nop 0
    buffer_load_dwordx4 v24, s[16:19], s39 offen offset:0  lds
    v_mfma_f32_16x16x32_bf16 v[76:79], v[140:143], v[172:175], v[76:79]
    ds_read_b64_tr_b16 v[116:117], v37 offset:0
    ds_read_b64_tr_b16 v[118:119], v37 offset:1536
    v_mfma_f32_16x16x32_bf16 v[80:83], v[144:147], v[168:171], v[80:83]
    ds_read_b64_tr_b16 v[120:121], v36 offset:128
    ds_read_b64_tr_b16 v[122:123], v36 offset:1664
    v_mfma_f32_16x16x32_bf16 v[88:91], v[144:147], v[172:175], v[88:91]
    buffer_load_dwordx4 v25, s[16:19], s39 offen offset:1024  lds
    s_add_u32 m0, s44, 32768
    s_nop 0
    v_mfma_f32_16x16x32_bf16 v[84:87], v[148:151], v[168:171], v[84:87]
    ds_read_b64_tr_b16 v[124:125], v37 offset:128
    ds_read_b64_tr_b16 v[126:127], v37 offset:1664
    v_mfma_f32_16x16x32_bf16 v[92:95], v[148:151], v[172:175], v[92:95]
    ds_read_b64_tr_b16 v[128:129], v36 offset:256
    ds_read_b64_tr_b16 v[130:131], v36 offset:1792
    v_mfma_f32_16x16x32_bf16 v[96:99], v[152:155], v[168:171], v[96:99]
    buffer_load_dwordx4 v26, s[20:23], s40 offen offset:0  lds
    v_mfma_f32_16x16x32_bf16 v[104:107], v[152:155], v[172:175], v[104:107]
    ds_read_b64_tr_b16 v[132:133], v37 offset:256
    ds_read_b64_tr_b16 v[134:135], v37 offset:1792
    v_mfma_f32_16x16x32_bf16 v[100:103], v[156:159], v[168:171], v[100:103]
    v_mfma_f32_16x16x32_bf16 v[108:111], v[156:159], v[172:175], v[108:111]
    buffer_load_dwordx4 v27, s[20:23], s40 offen offset:1024  lds
    s_waitcnt lgkmcnt(13)
    v_mfma_f32_16x16x32_bf16 v[64:67], v[112:115], v[160:163], v[64:67]
    ds_read_b128 v[168:171], v43 offset:0
    ds_read_b64_tr_b16 v[136:137], v36 offset:16384
    s_waitcnt lgkmcnt(14)
    v_mfma_f32_16x16x32_bf16 v[72:75], v[112:115], v[164:167], v[72:75]
    ds_read_b64_tr_b16 v[138:139], v36 offset:17920
    ds_read_b128 v[172:175], v43 offset:8192
    s_waitcnt lgkmcnt(12)
    v_mfma_f32_16x16x32_bf16 v[68:71], v[116:119], v[160:163], v[68:71]
    buffer_load_dwordx4 v28, s[20:23], s40 offen offset:2048  lds
    buffer_load_dwordx4 v29, s[20:23], s40 offen offset:3072  lds
    s_add_u32 m0, s44, 36864
    s_nop 0
    v_mfma_f32_16x16x32_bf16 v[76:79], v[116:119], v[164:167], v[76:79]
    ds_read_b64_tr_b16 v[140:141], v37 offset:16384
    ds_read_b64_tr_b16 v[142:143], v37 offset:17920
    s_waitcnt lgkmcnt(12)
    v_mfma_f32_16x16x32_bf16 v[80:83], v[120:123], v[160:163], v[80:83]
    ds_read_b64_tr_b16 v[144:145], v36 offset:16512
    ds_read_b64_tr_b16 v[146:147], v36 offset:18048
    v_mfma_f32_16x16x32_bf16 v[88:91], v[120:123], v[164:167], v[88:91]
    buffer_load_dwordx4 v30, s[20:23], s40 offen offset:0  lds
    s_waitcnt lgkmcnt(12)
    v_mfma_f32_16x16x32_bf16 v[84:87], v[124:127], v[160:163], v[84:87]
    ds_read_b64_tr_b16 v[148:149], v37 offset:16512
    ds_read_b64_tr_b16 v[150:151], v37 offset:18048
    v_mfma_f32_16x16x32_bf16 v[92:95], v[124:127], v[164:167], v[92:95]
    ds_read_b64_tr_b16 v[152:153], v36 offset:16640
    ds_read_b64_tr_b16 v[154:155], v36 offset:18176
    s_waitcnt lgkmcnt(14)
    v_mfma_f32_16x16x32_bf16 v[96:99], v[128:131], v[160:163], v[96:99]
    buffer_load_dwordx4 v31, s[20:23], s40 offen offset:1024  lds
    s_add_u32 s39, s39, 128
    s_add_u32 s40, s40, 196608
    s_cmp_eq_u32 s39, s43
    s_cselect_b32 s39, s41, s39
    s_cselect_b32 s40, s42, s40
    v_mfma_f32_16x16x32_bf16 v[104:107], v[128:131], v[164:167], v[104:107]
    ds_read_b64_tr_b16 v[156:157], v37 offset:16640
    ds_read_b64_tr_b16 v[158:159], v37 offset:18176
    s_waitcnt lgkmcnt(14)
    v_mfma_f32_16x16x32_bf16 v[100:103], v[132:135], v[160:163], v[100:103]
    v_mfma_f32_16x16x32_bf16 v[108:111], v[132:135], v[164:167], v[108:111]
    buffer_store_dwordx4 v[192:195], v1, s[32:35], s57 offen offset:0 sc1
    s_waitcnt vmcnt(9)
    s_waitcnt lgkmcnt(0)
    s_barrier
    v_mfma_f32_16x16x32_bf16 v[64:67], v[136:139], v[168:171], v[64:67]
L_w1:
    s_cbranch_execz L_wr
    ds_read_b128 v[160:163], v40 offset:0
    ds_read_b64_tr_b16 v[112:113], v34 offset:0
    v_mfma_f32_16x16x32_bf16 v[72:75], v[136:139], v[172:175], v[72:75]
    ds_read_b64_tr_b16 v[114:115], v34 offset:1536
    ds_read_b128 v[164:167], v40 offset:8192
    v_mfma_f32_16x16x32_bf16 v[68:71], v[140:143], v[168:171], v[68:71]
    s_add_u32 m0, s44, 71680
    s_nop 0
    buffer_load_dwordx4 v24, s[16:19], s39 offen offset:0  lds
    buffer_load_dwordx4 v25, s[16:19], s39 offen offset:1024  lds
    s_add_u32 m0, s44, 65536
    s_nop 0
    v_mfma_f32_16x16x32_bf16 v[76:79], v[140:143], v[172:175], v[76:79]
    ds_read_b64_tr_b16 v[116:117], v35 offset:0
    ds_read_b64_tr_b16 v[118:119], v35 offset:1536
    v_mfma_f32_16x16x32_bf16 v[80:83], v[144:147], v[168:171], v[80:83]
    ds_read_b64_tr_b16 v[120:121], v34 offset:128
    ds_read_b64_tr_b16 v[122:123], v34 offset:1664
    v_mfma_f32_16x16x32_bf16 v[88:91], v[144:147], v[172:175], v[88:91]
    buffer_load_dwordx4 v26, s[20:23], s40 offen offset:0  lds
    v_mfma_f32_16x16x32_bf16 v[84:87], v[148:151], v[168:171], v[84:87]
    ds_read_b64_tr_b16 v[124:125], v35 offset:128
    ds_read_b64_tr_b16 v[126:127], v35 offset:1664
    v_mfma_f32_16x16x32_bf16 v[92:95], v[148:151], v[172:175], v[92:95]
    ds_read_b64_tr_b16 v[128:129], v34 offset:256
    ds_read_b64_tr_b16 v[130:131], v34 offset:1792
    v_mfma_f32_16x16x32_bf16 v[96:99], v[152:155], v[168:171], v[96:99]
    buffer_load_dwordx4 v27, s[20:23], s40 offen offset:1024  lds
    v_mfma_f32_16x16x32_bf16 v[104:107], v[152:155], v[172:175], v[104:107]
    ds_read_b64_tr_b16 v[132:133], v35 offset:256
    ds_read_b64_tr_b16 v[134:135], v35 offset:1792
    v_mfma_f32_16x16x32_bf16 v[100:103], v[156:159], v[168:171], v[100:103]
    v_mfma_f32_16x16x32_bf16 v[108:111], v[156:159], v[172:175], v[108:111]
    buffer_load_dwordx4 v28, s[20:23], s40 offen offset:2048  lds
    s_waitcnt lgkmcnt(11)
    v_mfma_f32_16x16x32_bf16 v[64:67], v[112:115], v[160:163], v[64:67]
    ds_read_b128 v[168:171], v41 offset:0
    ds_read_b64_tr_b16 v[136:137], v34 offset:16384
    s_waitcnt lgkmcnt(12)
    v_mfma_f32_16x16x32_bf16 v[72:75], v[112:115], v[164:167], v[72:75]
    ds_read_b64_tr_b16 v[138:139], v34 offset:17920
    ds_read_b128 v[172:175], v41 offset:8192
    s_waitcnt lgkmcnt(12)
    v_mfma_f32_16x16x32_bf16 v[68:71], v[116:119], v[160:163], v[68:71]
    buffer_load_dwordx4 v29, s[20:23], s40 offen offset:3072  lds
    s_add_u32 m0, s44, 69632
    s_nop 0
    v_mfma_f32_16x16x32_bf16 v[76:79], v[116:119], v[164:167], v[76:79]
    ds_read_b64_tr_b16 v[140:141], v35 offset:16384
    ds_read_b64_tr_b16 v[142:143], v35 offset:17920
    s_waitcnt lgkmcnt(12)
    v_mfma_f32_16x16x32_bf16 v[80:83], v[120:123], v[160:163], v[80:83]
    ds_read_b64_tr_b16 v[144:145], v34 offset:16512
    ds_read_b64_tr_b16 v[146:147], v34 offset:18048
    v_mfma_f32_16x16x32_bf16 v[88:91], v[120:123], v[164:167], v[88:91]
    buffer_load_dwordx4 v30, s[20:23], s40 offen offset:0  lds
    s_waitcnt lgkmcnt(12)
    v_mfma_f32_16x16x32_bf16 v[84:87], v[124:127], v[160:163], v[84:87]
    ds_read_b64_tr_b16 v[148:149], v35 offset:16512
    ds_read_b64_tr_b16 v[150:151], v35 offset:18048
    v_mfma_f32_16x16x32_bf16 v[92:95], v[124:127], v[164:167], v[92:95]
    ds_read_b64_tr_b16 v[152:153], v34 offset:16640
    ds_read_b64_tr_b16 v[154:155], v34 offset:18176
    s_waitcnt lgkmcnt(14)
    v_mfma_f32_16x16x32_bf16 v[96:99], v[128:131], v[160:163], v[96:99]
    buffer_load_dwordx4 v31, s[20:23], s40 offen offset:1024  lds
    s_add_u32 s39, s39, 128
    s_add_u32 s40, s40, 196608
    s_cmp_eq_u32 s39, s43
    s_cselect_b32 s39, s41, s39
    s_cselect_b32 s40, s42, s40
    v_mfma_f32_16x16x32_bf16 v[104:107], v[128:131], v[164:167], v[104:107]
    ds_read_b64_tr_b16 v[156:157], v35 offset:16640
    ds_read_b64_tr_b16 v[158:159], v35 offset:18176
    s_waitcnt lgkmcnt(14)
    v_mfma_f32_16x16x32_bf16 v[100:103], v[132:135], v[160:163], v[100:103]
    v_mfma_f32_16x16x32_bf16 v[108:111], v[132:135], v[164:167], v[108:111]
    s_lshl_b32 s8, s2, 2
    s_add_u32 s8, s8, s36
    s_mul_i32 s8, s8, 1920
    v_lshlrev_b32 v250, 3, v1
    s_mov_b64 exec, 32767
    buffer_load_dword v251, v250, s[24:27], s8 offen
    s_mov_b64 exec, -1
    s_waitcnt vmcnt(10)
    s_waitcnt vmcnt(9)
    s_waitcnt lgkmcnt(0)
    s_barrier
    s_mul_i32 s48, s47, 0x9E3779B1
    s_add_u32 s48, s48, 0x7F4A7C15
    v_mov_b32 v17, s48
    s_mov_b64 exec, 3
    buffer_store_dword v17, v9, s[32:35], s14 offen sc1
    s_mov_b64 exec, -1
    v_mfma_f32_16x16x32_bf16 v[64:67], v[136:139], v[168:171], v[64:67]
    ds_read_b128 v[160:163], v40 offset:32768
    ds_read_b64_tr_b16 v[112:113], v34 offset:32768
    v_mfma_f32_16x16x32_bf16 v[72:75], v[136:139], v[172:175], v[72:75]
    ds_read_b64_tr_b16 v[114:115], v34 offset:34304
    ds_read_b128 v[164:167], v40 offset:40960
    v_mfma_f32_16x16x32_bf16 v[68:71], v[140:143], v[168:171], v[68:71]
    s_add_u32 m0, s44, 6144
    s_nop 0
    buffer_load_dwordx4 v24, s[16:19], s39 offen offset:0  lds
    v_mfma_f32_16x16x32_bf16 v[76:79], v[140:143], v[172:175], v[76:79]
    ds_read_b64_tr_b16 v[116:117], v35 offset:32768
    ds_read_b64_tr_b16 v[118:119], v35 offset:34304
    v_mfma_f32_16x16x32_bf16 v[80:83], v[144:147], v[168:171], v[80:83]
    ds_read_b64_tr_b16 v[120:121], v34 offset:32896
    ds_read_b64_tr_b16 v[122:123], v34 offset:34432
    v_mfma_f32_16x16x32_bf16 v[88:91], v[144:147], v[172:175], v[88:91]
    buffer_load_dwordx4 v25, s[16:19], s39 offen offset:1024  lds
    s_add_u32 m0, s44, 0
    s_nop 0
    v_mfma_f32_16x16x32_bf16 v[84:87], v[148:151], v[168:171], v[84:87]
    ds_read_b64_tr_b16 v[124:125], v35 offset:32896
    ds_read_b64_tr_b16 v[126:127], v35 offset:34432
    v_mfma_f32_16x16x32_bf16 v[92:95], v[148:151], v[172:175], v[92:95]
    ds_read_b64_tr_b16 v[128:129], v34 offset:33024
    ds_read_b64_tr_b16 v[130:131], v34 offset:34560
    v_mfma_f32_16x16x32_bf16 v[96:99], v[152:155], v[168:171], v[96:99]
    buffer_load_dwordx4 v26, s[20:23], s40 offen offset:0  lds
    v_mfma_f32_16x16x32_bf16 v[104:107], v[152:155], v[172:175], v[104:107]
    ds_read_b64_tr_b16 v[132:133], v35 offset:33024
    ds_read_b64_tr_b16 v[134:135], v35 offset:34560
    v_mfma_f32_16x16x32_bf16 v[100:103], v[156:159], v[168:171], v[100:103]
    v_mfma_f32_16x16x32_bf16 v[108:111], v[156:159], v[172:175], v[108:111]
    buffer_load_dwordx4 v27, s[20:23], s40 offen offset:1024  lds
    s_waitcnt lgkmcnt(11)
    v_mfma_f32_16x16x32_bf16 v[64:67], v[112:115], v[160:163], v[64:67]
    ds_read_b128 v[168:171], v41 offset:32768
    ds_read_b64_tr_b16 v[136:137], v34 offset:49152
    s_waitcnt lgkmcnt(12)
    v_mfma_f32_16x16x32_bf16 v[72:75], v[112:115], v[164:167], v[72:75]
    ds_read_b64_tr_b16 v[138:139], v34 offset:50688
    ds_read_b128 v[172:175], v41 offset:40960
    s_waitcnt lgkmcnt(12)
    v_mfma_f32_16x16x32_bf16 v[68:71], v[116:119], v[160:163], v[68:71]
    buffer_load_dwordx4 v28, s[20:23], s40 offen offset:2048  lds
    v_mfma_f32_16x16x32_bf16 v[76:79], v[116:119], v[164:167], v[76:79]
    ds_read_b64_tr_b16 v[140:141], v35 offset:49152
    ds_read_b64_tr_b16 v[142:143], v35 offset:50688
    s_waitcnt lgkmcnt(12)
    v_mfma_f32_16x16x32_bf16 v[80:83], v[120:123], v[160:163], v[80:83]
    ds_read_b64_tr_b16 v[144:145], v34 offset:49280
    ds_read_b64_tr_b16 v[146:147], v34 offset:50816
    v_mfma_f32_16x16x32_bf16 v[88:91], v[120:123], v[164:167], v[88:91]
    buffer_load_dwordx4 v29, s[20:23], s40 offen offset:3072  lds
    s_add_u32 m0, s44, 4096
    s_nop 0
    s_waitcnt lgkmcnt(12)
    v_mfma_f32_16x16x32_bf16 v[84:87], v[124:127], v[160:163], v[84:87]
    ds_read_b64_tr_b16 v[148:149], v35 offset:49280
    ds_read_b64_tr_b16 v[150:151], v35 offset:50816
    v_mfma_f32_16x16x32_bf16 v[92:95], v[124:127], v[164:167], v[92:95]
    ds_read_b64_tr_b16 v[152:153], v34 offset:49408
    ds_read_b64_tr_b16 v[154:155], v34 offset:50944
    s_waitcnt lgkmcnt(14)
    v_mfma_f32_16x16x32_bf16 v[96:99], v[128:131], v[160:163], v[96:99]
    buffer_load_dwordx4 v30, s[20:23], s40 offen offset:0  lds
    v_mfma_f32_16x16x32_bf16 v[104:107], v[128:131], v[164:167], v[104:107]
    ds_read_b64_tr_b16 v[156:157], v35 offset:49408
    ds_read_b64_tr_b16 v[158:159], v35 offset:50944
    s_waitcnt lgkmcnt(14)
    v_mfma_f32_16x16x32_bf16 v[100:103], v[132:135], v[160:163], v[100:103]
    v_mfma_f32_16x16x32_bf16 v[108:111], v[132:135], v[164:167], v[108:111]
    buffer_load_dwordx4 v31, s[20:23], s40 offen offset:1024  lds
    s_add_u32 s39, s39, 128
    s_add_u32 s40, s40, 196608
    s_cmp_eq_u32 s39, s43
    s_cselect_b32 s39, s41, s39
    s_cselect_b32 s40, s42, s40
    s_waitcnt vmcnt(10)
    s_waitcnt lgkmcnt(0)
    s_barrier
    v_mfma_f32_16x16x32_bf16 v[64:67], v[136:139], v[168:171], v[64:67]
    ds_read_b128 v[160:163], v42 offset:0
    ds_read_b64_tr_b16 v[112:113], v36 offset:0
    v_mfma_f32_16x16x32_bf16 v[72:75], v[136:139], v[172:175], v[72:75]
    ds_read_b64_tr_b16 v[114:115], v36 offset:1536
    ds_read_b128 v[164:167], v42 offset:8192
    v_mfma_f32_16x16x32_bf16 v[68:71], v[140:143], v[168:171], v[68:71]
    s_add_u32 m0, s44, 38912
    s_nop 0
    buffer_load_dwordx4 v24, s[16:19], s39 offen offset:0  lds
    v_mfma_f32_16x16x32_bf16 v[76:79], v[140:143], v[172:175], v[76:79]
    ds_read_b64_tr_b16 v[116:117], v37 offset:0
    ds_read_b64_tr_b16 v[118:119], v37 offset:1536
    v_mfma_f32_16x16x32_bf16 v[80:83], v[144:147], v[168:171], v[80:83]
    ds_read_b64_tr_b16 v[120:121], v36 offset:128
    ds_read_b64_tr_b16 v[122:123], v36 offset:1664
    v_mfma_f32_16x16x32_bf16 v[88:91], v[144:147], v[172:175], v[88:91]
    buffer_load_dwordx4 v25, s[16:19], s39 offen offset:1024  lds
    s_add_u32 m0, s44, 32768
    s_nop 0
    v_mfma_f32_16x16x32_bf16 v[84:87], v[148:151], v[168:171], v[84:87]
    ds_read_b64_tr_b16 v[124:125], v37 offset:128
    ds_read_b64_tr_b16 v[126:127], v37 offset:1664
    v_mfma_f32_16x16x32_bf16 v[92:95], v[148:151], v[172:175], v[92:95]
    ds_read_b64_tr_b16 v[128:129], v36 offset:256
    ds_read_b64_tr_b16 v[130:131], v36 offset:1792
    v_mfma_f32_16x16x32_bf16 v[96:99], v[152:155], v[168:171], v[96:99]
    buffer_load_dwordx4 v26, s[20:23], s40 offen offset:0  lds
    v_mfma_f32_16x16x32_bf16 v[104:107], v[152:155], v[172:175], v[104:107]
    ds_read_b64_tr_b16 v[132:133], v37 offset:256
    ds_read_b64_tr_b16 v[134:135], v37 offset:1792
    v_mfma_f32_16x16x32_bf16 v[100:103], v[156:159], v[168:171], v[100:103]
    v_mfma_f32_16x16x32_bf16 v[108:111], v[156:159], v[172:175], v[108:111]
    buffer_load_dwordx4 v27, s[20:23], s40 offen offset:1024  lds
    s_waitcnt lgkmcnt(11)
    v_mfma_f32_16x16x32_bf16 v[64:67], v[112:115], v[160:163], v[64:67]
    ds_read_b128 v[168:171], v43 offset:0
    ds_read_b64_tr_b16 v[136:137], v36 offset:16384
    s_waitcnt lgkmcnt(12)
    v_mfma_f32_16x16x32_bf16 v[72:75], v[112:115], v[164:167], v[72:75]
    ds_read_b64_tr_b16 v[138:139], v36 offset:17920
    ds_read_b128 v[172:175], v43 offset:8192
    s_waitcnt lgkmcnt(12)
    v_mfma_f32_16x16x32_bf16 v[68:71], v[116:119], v[160:163], v[68:71]
    buffer_load_dwordx4 v28, s[20:23], s40 offen offset:2048  lds
    v_mfma_f32_16x16x32_bf16 v[76:79], v[116:119], v[164:167], v[76:79]
    ds_read_b64_tr_b16 v[140:141], v37 offset:16384
    ds_read_b64_tr_b16 v[142:143], v37 offset:17920
    s_waitcnt lgkmcnt(12)
    v_mfma_f32_16x16x32_bf16 v[80:83], v[120:123], v[160:163], v[80:83]
    ds_read_b64_tr_b16 v[144:145], v36 offset:16512
    ds_read_b64_tr_b16 v[146:147], v36 offset:18048
    v_mfma_f32_16x16x32_bf16 v[88:91], v[120:123], v[164:167], v[88:91]
    buffer_load_dwordx4 v29, s[20:23], s40 offen offset:3072  lds
    s_add_u32 m0, s44, 36864
    s_nop 0
    s_waitcnt lgkmcnt(12)
    v_mfma_f32_16x16x32_bf16 v[84:87], v[124:127], v[160:163], v[84:87]
    ds_read_b64_tr_b16 v[148:149], v37 offset:16512
    ds_read_b64_tr_b16 v[150:151], v37 offset:18048
    v_mfma_f32_16x16x32_bf16 v[92:95], v[124:127], v[164:167], v[92:95]
    ds_read_b64_tr_b16 v[152:153], v36 offset:16640
    ds_read_b64_tr_b16 v[154:155], v36 offset:18176
    s_waitcnt lgkmcnt(14)
    v_mfma_f32_16x16x32_bf16 v[96:99], v[128:131], v[160:163], v[96:99]
    buffer_load_dwordx4 v30, s[20:23], s40 offen offset:0  lds
    v_mfma_f32_16x16x32_bf16 v[104:107], v[128:131], v[164:167], v[104:107]
    ds_read_b64_tr_b16 v[156:157], v37 offset:16640
    ds_read_b64_tr_b16 v[158:159], v37 offset:18176
    s_waitcnt lgkmcnt(14)
    v_mfma_f32_16x16x32_bf16 v[100:103], v[132:135], v[160:163], v[100:103]
    v_mfma_f32_16x16x32_bf16 v[108:111], v[132:135], v[164:167], v[108:111]
    buffer_load_dwordx4 v31, s[20:23], s40 offen offset:1024  lds
    s_add_u32 s39, s39, 128
    s_add_u32 s40, s40, 196608
    s_cmp_eq_u32 s39, s43
    s_cselect_b32 s39, s41, s39
    s_cselect_b32 s40, s42, s40
    s_waitcnt vmcnt(8)
    s_waitcnt lgkmcnt(0)
    s_barrier
    v_mfma_f32_16x16x32_bf16 v[64:67], v[136:139], v[168:171], v[64:67]
    ds_read_b128 v[160:163], v40 offset:0
    ds_read_b64_tr_b16 v[112:113], v34 offset:0
    v_mfma_f32_16x16x32_bf16 v[72:75], v[136:139], v[172:175], v[72:75]
    ds_read_b64_tr_b16 v[114:115], v34 offset:1536
    ds_read_b128 v[164:167], v40 offset:8192
    v_mfma_f32_16x16x32_bf16 v[68:71], v[140:143], v[168:171], v[68:71]
    s_add_u32 m0, s44, 71680
    s_nop 0
    buffer_load_dwordx4 v24, s[16:19], s39 offen offset:0  lds
    v_mfma_f32_16x16x32_bf16 v[76:79], v[140:143], v[172:175], v[76:79]
    ds_read_b64_tr_b16 v[116:117], v35 offset:0
    ds_read_b64_tr_b16 v[118:119], v35 offset:1536
    v_mfma_f32_16x16x32_bf16 v[80:83], v[144:147], v[168:171], v[80:83]
    ds_read_b64_tr_b16 v[120:121], v34 offset:128
    ds_read_b64_tr_b16 v[122:123], v34 offset:1664
    v_mfma_f32_16x16x32_bf16 v[88:91], v[144:147], v[172:175], v[88:91]
    buffer_load_dwordx4 v25, s[16:19], s39 offen offset:1024  lds
    s_add_u32 m0, s44, 65536
    s_nop 0
    v_mfma_f32_16x16x32_bf16 v[84:87], v[148:151], v[168:171], v[84:87]
    ds_read_b64_tr_b16 v[124:125], v35 offset:128
    ds_read_b64_tr_b16 v[126:127], v35 offset:1664
    v_mfma_f32_16x16x32_bf16 v[92:95], v[148:151], v[172:175], v[92:95]
    ds_read_b64_tr_b16 v[128:129], v34 offset:256
    ds_read_b64_tr_b16 v[130:131], v34 offset:1792
    v_mfma_f32_16x16x32_bf16 v[96:99], v[152:155], v[168:171], v[96:99]
    buffer_load_dwordx4 v26, s[20:23], s40 offen offset:0  lds
    v_mfma_f32_16x16x32_bf16 v[104:107], v[152:155], v[172:175], v[104:107]
    ds_read_b64_tr_b16 v[132:133], v35 offset:256
    ds_read_b64_tr_b16 v[134:135], v35 offset:1792
    v_mfma_f32_16x16x32_bf16 v[100:103], v[156:159], v[168:171], v[100:103]
    v_mfma_f32_16x16x32_bf16 v[108:111], v[156:159], v[172:175], v[108:111]
    buffer_load_dwordx4 v27, s[20:23], s40 offen offset:1024  lds
    s_waitcnt lgkmcnt(11)
    v_mfma_f32_16x16x32_bf16 v[64:67], v[112:115], v[160:163], v[64:67]
    ds_read_b128 v[168:171], v41 offset:0
    ds_read_b64_tr_b16 v[136:137], v34 offset:16384
    s_waitcnt lgkmcnt(12)
    v_mfma_f32_16x16x32_bf16 v[72:75], v[112:115], v[164:167], v[72:75]
    ds_read_b64_tr_b16 v[138:139], v34 offset:17920
    ds_read_b128 v[172:175], v41 offset:8192
    s_waitcnt lgkmcnt(12)
    v_mfma_f32_16x16x32_bf16 v[68:71], v[116:119], v[160:163], v[68:71]
    buffer_load_dwordx4 v28, s[20:23], s40 offen offset:2048  lds
    v_mfma_f32_16x16x32_bf16 v[76:79], v[116:119], v[164:167], v[76:79]
    ds_read_b64_tr_b16 v[140:141], v35 offset:16384
    ds_read_b64_tr_b16 v[142:143], v35 offset:17920
    s_waitcnt lgkmcnt(12)
    v_mfma_f32_16x16x32_bf16 v[80:83], v[120:123], v[160:163], v[80:83]
    ds_read_b64_tr_b16 v[144:145], v34 offset:16512
    ds_read_b64_tr_b16 v[146:147], v34 offset:18048
    v_mfma_f32_16x16x32_bf16 v[88:91], v[120:123], v[164:167], v[88:91]
    buffer_load_dwordx4 v29, s[20:23], s40 offen offset:3072  lds
    s_add_u32 m0, s44, 69632
    s_nop 0
    s_waitcnt lgkmcnt(12)
    v_mfma_f32_16x16x32_bf16 v[84:87], v[124:127], v[160:163], v[84:87]
    ds_read_b64_tr_b16 v[148:149], v35 offset:16512
    ds_read_b64_tr_b16 v[150:151], v35 offset:18048
    v_mfma_f32_16x16x32_bf16 v[92:95], v[124:127], v[164:167], v[92:95]
    ds_read_b64_tr_b16 v[152:153], v34 offset:16640
    ds_read_b64_tr_b16 v[154:155], v34 offset:18176
    s_waitcnt lgkmcnt(14)
    v_mfma_f32_16x16x32_bf16 v[96:99], v[128:131], v[160:163], v[96:99]
    buffer_load_dwordx4 v30, s[20:23], s40 offen offset:0  lds
    v_mfma_f32_16x16x32_bf16 v[104:107], v[128:131], v[164:167], v[104:107]
    ds_read_b64_tr_b16 v[156:157], v35 offset:16640
    ds_read_b64_tr_b16 v[158:159], v35 offset:18176
    s_waitcnt lgkmcnt(14)
    v_mfma_f32_16x16x32_bf16 v[100:103], v[132:135], v[160:163], v[100:103]
    v_mfma_f32_16x16x32_bf16 v[108:111], v[132:135], v[164:167], v[108:111]
    buffer_load_dwordx4 v31, s[20:23], s40 offen offset:1024  lds
    s_add_u32 s39, s39, 128
    s_add_u32 s40, s40, 196608
    s_cmp_eq_u32 s39, s43
    s_cselect_b32 s39, s41, s39
    s_cselect_b32 s40, s42, s40
    s_waitcnt vmcnt(8)
    s_waitcnt lgkmcnt(0)
    s_barrier
    v_mfma_f32_16x16x32_bf16 v[64:67], v[136:139], v[168:171], v[64:67]
    ds_read_b128 v[160:163], v40 offset:32768
    ds_read_b64_tr_b16 v[112:113], v34 offset:32768
    v_mfma_f32_16x16x32_bf16 v[72:75], v[136:139], v[172:175], v[72:75]
    ds_read_b64_tr_b16 v[114:115], v34 offset:34304
    ds_read_b128 v[164:167], v40 offset:40960
    v_mfma_f32_16x16x32_bf16 v[68:71], v[140:143], v[168:171], v[68:71]
    s_add_u32 m0, s44, 6144
    s_nop 0
    buffer_load_dwordx4 v24, s[16:19], s39 offen offset:0  lds
    v_mfma_f32_16x16x32_bf16 v[76:79], v[140:143], v[172:175], v[76:79]
    ds_read_b64_tr_b16 v[116:117], v35 offset:32768
    ds_read_b64_tr_b16 v[118:119], v35 offset:34304
    v_mfma_f32_16x16x32_bf16 v[80:83], v[144:147], v[168:171], v[80:83]
    ds_read_b64_tr_b16 v[120:121], v34 offset:32896
    ds_read_b64_tr_b16 v[122:123], v34 offset:34432
    v_mfma_f32_16x16x32_bf16 v[88:91], v[144:147], v[172:175], v[88:91]
    buffer_load_dwordx4 v25, s[16:19], s39 offen offset:1024  lds
    s_add_u32 m0, s44, 0
    s_nop 0
    v_mfma_f32_16x16x32_bf16 v[84:87], v[148:151], v[168:171], v[84:87]
    ds_read_b64_tr_b16 v[124:125], v35 offset:32896
    ds_read_b64_tr_b16 v[126:127], v35 offset:34432
    v_mfma_f32_16x16x32_bf16 v[92:95], v[148:151], v[172:175], v[92:95]
    ds_read_b64_tr_b16 v[128:129], v34 offset:33024
    ds_read_b64_tr_b16 v[130:131], v34 offset:34560
    v_mfma_f32_16x16x32_bf16 v[96:99], v[152:155], v[168:171], v[96:99]
    buffer_load_dwordx4 v26, s[20:23], s40 offen offset:0  lds
    v_mfma_f32_16x16x32_bf16 v[104:107], v[152:155], v[172:175], v[104:107]
    ds_read_b64_tr_b16 v[132:133], v35 offset:33024
    ds_read_b64_tr_b16 v[134:135], v35 offset:34560
    v_mfma_f32_16x16x32_bf16 v[100:103], v[156:159], v[168:171], v[100:103]
    v_mfma_f32_16x16x32_bf16 v[108:111], v[156:159], v[172:175], v[108:111]
    buffer_load_dwordx4 v27, s[20:23], s40 offen offset:1024  lds
    s_waitcnt lgkmcnt(11)
    v_mfma_f32_16x16x32_bf16 v[64:67], v[112:115], v[160:163], v[64:67]
    ds_read_b128 v[168:171], v41 offset:32768
    ds_read_b64_tr_b16 v[136:137], v34 offset:49152
    s_waitcnt lgkmcnt(12)
    v_mfma_f32_16x16x32_bf16 v[72:75], v[112:115], v[164:167], v[72:75]
    ds_read_b64_tr_b16 v[138:139], v34 offset:50688
    ds_read_b128 v[172:175], v41 offset:40960
    s_waitcnt lgkmcnt(12)
    v_mfma_f32_16x16x32_bf16 v[68:71], v[116:119], v[160:163], v[68:71]
    buffer_load_dwordx4 v28, s[20:23], s40 offen offset:2048  lds
    v_mfma_f32_16x16x32_bf16 v[76:79], v[116:119], v[164:167], v[76:79]
    ds_read_b64_tr_b16 v[140:141], v35 offset:49152
    ds_read_b64_tr_b16 v[142:143], v35 offset:50688
    s_waitcnt lgkmcnt(12)
    v_mfma_f32_16x16x32_bf16 v[80:83], v[120:123], v[160:163], v[80:83]
    ds_read_b64_tr_b16 v[144:145], v34 offset:49280
    ds_read_b64_tr_b16 v[146:147], v34 offset:50816
    v_mfma_f32_16x16x32_bf16 v[88:91], v[120:123], v[164:167], v[88:91]
    buffer_load_dwordx4 v29, s[20:23], s40 offen offset:3072  lds
    s_add_u32 m0, s44, 4096
    s_nop 0
    s_waitcnt lgkmcnt(12)
    v_mfma_f32_16x16x32_bf16 v[84:87], v[124:127], v[160:163], v[84:87]
    ds_read_b64_tr_b16 v[148:149], v35 offset:49280
    ds_read_b64_tr_b16 v[150:151], v35 offset:50816
    v_mfma_f32_16x16x32_bf16 v[92:95], v[124:127], v[164:167], v[92:95]
    ds_read_b64_tr_b16 v[152:153], v34 offset:49408
    ds_read_b64_tr_b16 v[154:155], v34 offset:50944
    s_waitcnt lgkmcnt(14)
    v_mfma_f32_16x16x32_bf16 v[96:99], v[128:131], v[160:163], v[96:99]
    buffer_load_dwordx4 v30, s[20:23], s40 offen offset:0  lds
    v_mfma_f32_16x16x32_bf16 v[104:107], v[128:131], v[164:167], v[104:107]
    ds_read_b64_tr_b16 v[156:157], v35 offset:49408
    ds_read_b64_tr_b16 v[158:159], v35 offset:50944
    s_waitcnt lgkmcnt(14)
    v_mfma_f32_16x16x32_bf16 v[100:103], v[132:135], v[160:163], v[100:103]
    v_mfma_f32_16x16x32_bf16 v[108:111], v[132:135], v[164:167], v[108:111]
    buffer_load_dwordx4 v31, s[20:23], s40 offen offset:1024  lds
    s_waitcnt vmcnt(8)
    s_waitcnt lgkmcnt(0)
    s_barrier
    v_mfma_f32_16x16x32_bf16 v[64:67], v[136:139], v[168:171], v[64:67]
    ds_read_b128 v[160:163], v42 offset:0
    ds_read_b64_tr_b16 v[112:113], v36 offset:0
    v_mfma_f32_16x16x32_bf16 v[72:75], v[136:139], v[172:175], v[72:75]
    ds_read_b64_tr_b16 v[114:115], v36 offset:1536
    ds_read_b128 v[164:167], v42 offset:8192
    v_mfma_f32_16x16x32_bf16 v[68:71], v[140:143], v[168:171], v[68:71]
    s_mul_i32 s58, s60, 40
    s_add_u32 m0, s44, 98304
    s_add_u32 s58, s58, s53
    buffer_load_dwordx4 v56, s[24:27], s58 offen offset:0  lds
    v_mfma_f32_16x16x32_bf16 v[76:79], v[140:143], v[172:175], v[76:79]
    ds_read_b64_tr_b16 v[116:117], v37 offset:0
    ds_read_b64_tr_b16 v[118:119], v37 offset:1536
    v_mfma_f32_16x16x32_bf16 v[80:83], v[144:147], v[168:171], v[80:83]
    ds_read_b64_tr_b16 v[120:121], v36 offset:128
    ds_read_b64_tr_b16 v[122:123], v36 offset:1664
    v_mfma_f32_16x16x32_bf16 v[88:91], v[144:147], v[172:175], v[88:91]
    buffer_load_dwordx4 v57, s[24:27], s58 offen offset:1024  lds
    v_mfma_f32_16x16x32_bf16 v[84:87], v[148:151], v[168:171], v[84:87]
    ds_read_b64_tr_b16 v[124:125], v37 offset:128
    ds_read_b64_tr_b16 v[126:127], v37 offset:1664
    v_mfma_f32_16x16x32_bf16 v[92:95], v[148:151], v[172:175], v[92:95]
    ds_read_b64_tr_b16 v[128:129], v36 offset:256
    ds_read_b64_tr_b16 v[130:131], v36 offset:1792
    v_mfma_f32_16x16x32_bf16 v[96:99], v[152:155], v[168:171], v[96:99]
    buffer_load_dwordx4 v58, s[24:27], s58 offen offset:2048  lds
    v_mfma_f32_16x16x32_bf16 v[104:107], v[152:155], v[172:175], v[104:107]
    ds_read_b64_tr_b16 v[132:133], v37 offset:256
    ds_read_b64_tr_b16 v[134:135], v37 offset:1792
    v_mfma_f32_16x16x32_bf16 v[100:103], v[156:159], v[168:171], v[100:103]
    v_mfma_f32_16x16x32_bf16 v[108:111], v[156:159], v[172:175], v[108:111]
    buffer_load_dwordx4 v59, s[24:27], s58 offen offset:3072  lds
    s_waitcnt lgkmcnt(11)
    v_mfma_f32_16x16x32_bf16 v[64:67], v[112:115], v[160:163], v[64:67]
    ds_read_b128 v[168:171], v43 offset:0
    ds_read_b64_tr_b16 v[136:137], v36 offset:16384
    s_waitcnt lgkmcnt(12)
    v_mfma_f32_16x16x32_bf16 v[72:75], v[112:115], v[164:167], v[72:75]
    ds_read_b64_tr_b16 v[138:139], v36 offset:17920
    ds_read_b128 v[172:175], v43 offset:8192
    s_waitcnt lgkmcnt(12)
    v_mfma_f32_16x16x32_bf16 v[68:71], v[116:119], v[160:163], v[68:71]
    s_mul_i32 s58, s61, 40
    s_add_u32 m0, s44, 102400
    s_add_u32 s58, s58, s53
    buffer_load_dwordx4 v56, s[24:27], s58 offen offset:0  lds
    v_mfma_f32_16x16x32_bf16 v[76:79], v[116:119], v[164:167], v[76:79]
    ds_read_b64_tr_b16 v[140:141], v37 offset:16384
    ds_read_b64_tr_b16 v[142:143], v37 offset:17920
    s_waitcnt lgkmcnt(12)
    v_mfma_f32_16x16x32_bf16 v[80:83], v[120:123], v[160:163], v[80:83]
    ds_read_b64_tr_b16 v[144:145], v36 offset:16512
    ds_read_b64_tr_b16 v[146:147], v36 offset:18048
    v_mfma_f32_16x16x32_bf16 v[88:91], v[120:123], v[164:167], v[88:91]
    buffer_load_dwordx4 v57, s[24:27], s58 offen offset:1024  lds
    s_waitcnt lgkmcnt(12)
    v_mfma_f32_16x16x32_bf16 v[84:87], v[124:127], v[160:163], v[84:87]
    ds_read_b64_tr_b16 v[148:149], v37 offset:16512
    ds_read_b64_tr_b16 v[150:151], v37 offset:18048
    v_mfma_f32_16x16x32_bf16 v[92:95], v[124:127], v[164:167], v[92:95]
    ds_read_b64_tr_b16 v[152:153], v36 offset:16640
    ds_read_b64_tr_b16 v[154:155], v36 offset:18176
    s_waitcnt lgkmcnt(14)
    v_mfma_f32_16x16x32_bf16 v[96:99], v[128:131], v[160:163], v[96:99]
    buffer_load_dwordx4 v58, s[24:27], s58 offen offset:2048  lds
    v_mfma_f32_16x16x32_bf16 v[104:107], v[128:131], v[164:167], v[104:107]
    ds_read_b64_tr_b16 v[156:157], v37 offset:16640
    ds_read_b64_tr_b16 v[158:159], v37 offset:18176
    s_waitcnt lgkmcnt(14)
    v_mfma_f32_16x16x32_bf16 v[100:103], v[132:135], v[160:163], v[100:103]
    v_mfma_f32_16x16x32_bf16 v[108:111], v[132:135], v[164:167], v[108:111]
    buffer_load_dwordx4 v59, s[24:27], s58 offen offset:3072  lds
    s_waitcnt vmcnt(8)
    s_waitcnt lgkmcnt(0)
    s_barrier
    v_mfma_f32_16x16x32_bf16 v[64:67], v[136:139], v[168:171], v[64:67]
    ds_read_b128 v[160:163], v40 offset:0
    ds_read_b64_tr_b16 v[112:113], v34 offset:0
    v_mfma_f32_16x16x32_bf16 v[72:75], v[136:139], v[172:175], v[72:75]
    ds_read_b64_tr_b16 v[114:115], v34 offset:1536
    ds_read_b128 v[164:167], v40 offset:8192
    v_mfma_f32_16x16x32_bf16 v[68:71], v[140:143], v[168:171], v[68:71]
    s_mul_i32 s58, s62, 40
    s_add_u32 m0, s44, 131072
    s_add_u32 s58, s58, s53
    buffer_load_dwordx4 v56, s[24:27], s58 offen offset:0  lds
    v_mfma_f32_16x16x32_bf16 v[76:79], v[140:143], v[172:175], v[76:79]
    ds_read_b64_tr_b16 v[116:117], v35 offset:0
    ds_read_b64_tr_b16 v[118:119], v35 offset:1536
    v_mfma_f32_16x16x32_bf16 v[80:83], v[144:147], v[168:171], v[80:83]
    ds_read_b64_tr_b16 v[120:121], v34 offset:128
    ds_read_b64_tr_b16 v[122:123], v34 offset:1664
    v_mfma_f32_16x16x32_bf16 v[88:91], v[144:147], v[172:175], v[88:91]
    buffer_load_dwordx4 v57, s[24:27], s58 offen offset:1024  lds
    v_mfma_f32_16x16x32_bf16 v[84:87], v[148:151], v[168:171], v[84:87]
    ds_read_b64_tr_b16 v[124:125], v35 offset:128
    ds_read_b64_tr_b16 v[126:127], v35 offset:1664
    v_mfma_f32_16x16x32_bf16 v[92:95], v[148:151], v[172:175], v[92:95]
    ds_read_b64_tr_b16 v[128:129], v34 offset:256
    ds_read_b64_tr_b16 v[130:131], v34 offset:1792
    v_mfma_f32_16x16x32_bf16 v[96:99], v[152:155], v[168:171], v[96:99]
    buffer_load_dwordx4 v58, s[24:27], s58 offen offset:2048  lds
    v_mfma_f32_16x16x32_bf16 v[104:107], v[152:155], v[172:175], v[104:107]
    ds_read_b64_tr_b16 v[132:133], v35 offset:256
    ds_read_b64_tr_b16 v[134:135], v35 offset:1792
    v_mfma_f32_16x16x32_bf16 v[100:103], v[156:159], v[168:171], v[100:103]
    v_mfma_f32_16x16x32_bf16 v[108:111], v[156:159], v[172:175], v[108:111]
    buffer_load_dwordx4 v59, s[24:27], s58 offen offset:3072  lds
    s_waitcnt lgkmcnt(11)
    v_mfma_f32_16x16x32_bf16 v[64:67], v[112:115], v[160:163], v[64:67]
    ds_read_b128 v[168:171], v41 offset:0
    ds_read_b64_tr_b16 v[136:137], v34 offset:16384
    s_waitcnt lgkmcnt(12)
    v_mfma_f32_16x16x32_bf16 v[72:75], v[112:115], v[164:167], v[72:75]
    ds_read_b64_tr_b16 v[138:139], v34 offset:17920
    ds_read_b128 v[172:175], v41 offset:8192
    s_waitcnt lgkmcnt(12)
    v_mfma_f32_16x16x32_bf16 v[68:71], v[116:119], v[160:163], v[68:71]
    s_mul_i32 s58, s63, 40
    s_add_u32 m0, s44, 135168
    s_add_u32 s58, s58, s53
    buffer_load_dwordx4 v56, s[24:27], s58 offen offset:0  lds
    v_mfma_f32_16x16x32_bf16 v[76:79], v[116:119], v[164:167], v[76:79]
    ds_read_b64_tr_b16 v[140:141], v35 offset:16384
    ds_read_b64_tr_b16 v[142:143], v35 offset:17920
    s_waitcnt lgkmcnt(12)
    v_mfma_f32_16x16x32_bf16 v[80:83], v[120:123], v[160:163], v[80:83]
    ds_read_b64_tr_b16 v[144:145], v34 offset:16512
    ds_read_b64_tr_b16 v[146:147], v34 offset:18048
    v_mfma_f32_16x16x32_bf16 v[88:91], v[120:123], v[164:167], v[88:91]
    buffer_load_dwordx4 v57, s[24:27], s58 offen offset:1024  lds
    s_waitcnt lgkmcnt(12)
    v_mfma_f32_16x16x32_bf16 v[84:87], v[124:127], v[160:163], v[84:87]
    ds_read_b64_tr_b16 v[148:149], v35 offset:16512
    ds_read_b64_tr_b16 v[150:151], v35 offset:18048
    v_mfma_f32_16x16x32_bf16 v[92:95], v[124:127], v[164:167], v[92:95]
    ds_read_b64_tr_b16 v[152:153], v34 offset:16640
    ds_read_b64_tr_b16 v[154:155], v34 offset:18176
    s_waitcnt lgkmcnt(14)
    v_mfma_f32_16x16x32_bf16 v[96:99], v[128:131], v[160:163], v[96:99]
    buffer_load_dwordx4 v58, s[24:27], s58 offen offset:2048  lds
    v_mfma_f32_16x16x32_bf16 v[104:107], v[128:131], v[164:167], v[104:107]
    ds_read_b64_tr_b16 v[156:157], v35 offset:16640
    ds_read_b64_tr_b16 v[158:159], v35 offset:18176
    s_waitcnt lgkmcnt(14)
    v_mfma_f32_16x16x32_bf16 v[100:103], v[132:135], v[160:163], v[100:103]
    v_mfma_f32_16x16x32_bf16 v[108:111], v[132:135], v[164:167], v[108:111]
    buffer_load_dwordx4 v59, s[24:27], s58 offen offset:3072  lds
    s_waitcnt lgkmcnt(11)
    v_mfma_f32_16x16x32_bf16 v[64:67], v[136:139], v[168:171], v[64:67]
    s_waitcnt lgkmcnt(10)
    v_mfma_f32_16x16x32_bf16 v[72:75], v[136:139], v[172:175], v[72:75]
    s_waitcnt lgkmcnt(8)
    v_mfma_f32_16x16x32_bf16 v[68:71], v[140:143], v[168:171], v[68:71]
    v_mfma_f32_16x16x32_bf16 v[76:79], v[140:143], v[172:175], v[76:79]
L_w2:
    s_cbranch_execz L_wr
    s_waitcnt lgkmcnt(6)
    v_mfma_f32_16x16x32_bf16 v[80:83], v[144:147], v[168:171], v[80:83]
    v_mfma_f32_16x16x32_bf16 v[88:91], v[144:147], v[172:175], v[88:91]
    s_waitcnt lgkmcnt(4)
    v_mfma_f32_16x16x32_bf16 v[84:87], v[148:151], v[168:171], v[84:87]
    v_mfma_f32_16x16x32_bf16 v[92:95], v[148:151], v[172:175], v[92:95]
    s_waitcnt lgkmcnt(2)
    v_mfma_f32_16x16x32_bf16 v[96:99], v[152:155], v[168:171], v[96:99]
    v_mfma_f32_16x16x32_bf16 v[104:107], v[152:155], v[172:175], v[104:107]
    s_waitcnt lgkmcnt(0)
    v_mfma_f32_16x16x32_bf16 v[100:103], v[156:159], v[168:171], v[100:103]
    v_mfma_f32_16x16x32_bf16 v[108:111], v[156:159], v[172:175], v[108:111]
    v_pk_mul_f32 v[176:177], v[64:65], s[4:5]
    v_pk_mul_f32 v[178:179], v[66:67], s[4:5]
    v_pk_mul_f32 v[180:181], v[68:69], s[4:5]
    v_pk_mul_f32 v[182:183], v[70:71], s[4:5]
    v_exp_f32 v176, v176
    v_exp_f32 v177, v177
    v_exp_f32 v178, v178
    v_exp_f32 v179, v179
    v_exp_f32 v180, v180
    v_exp_f32 v181, v181
    v_exp_f32 v182, v182
    v_exp_f32 v183, v183
    v_pk_add_f32 v[176:177], v[176:177], 1.0 op_sel_hi:[1,0]
    v_pk_add_f32 v[178:179], v[178:179], 1.0 op_sel_hi:[1,0]
    v_pk_add_f32 v[180:181], v[180:181], 1.0 op_sel_hi:[1,0]
    v_pk_add_f32 v[182:183], v[182:183], 1.0 op_sel_hi:[1,0]
    v_rcp_f32 v176, v176
    v_rcp_f32 v177, v177
    v_rcp_f32 v178, v178
    v_rcp_f32 v179, v179
    v_rcp_f32 v180, v180
    v_rcp_f32 v181, v181
    v_rcp_f32 v182, v182
    v_rcp_f32 v183, v183
    v_pk_mul_f32 v[176:177], v[64:65], v[176:177]
    v_pk_mul_f32 v[178:179], v[66:67], v[178:179]
    v_pk_mul_f32 v[180:181], v[68:69], v[180:181]
    v_pk_mul_f32 v[182:183], v[70:71], v[182:183]
    v_cvt_pk_bf16_f32 v192, v176, v177
    v_cvt_pk_bf16_f32 v193, v178, v179
    v_cvt_pk_bf16_f32 v194, v180, v181
    v_cvt_pk_bf16_f32 v195, v182, v183
    buffer_store_dwordx4 v[192:195], v1, s[32:35], s49 offen offset:0 sc1
    v_pk_mul_f32 v[184:185], v[72:73], s[4:5]
    v_pk_mul_f32 v[186:187], v[74:75], s[4:5]
    v_pk_mul_f32 v[188:189], v[76:77], s[4:5]
    v_pk_mul_f32 v[190:191], v[78:79], s[4:5]
    v_exp_f32 v184, v184
    v_exp_f32 v185, v185
    v_exp_f32 v186, v186
    v_exp_f32 v187, v187
    v_exp_f32 v188, v188
    v_exp_f32 v189, v189
    v_exp_f32 v190, v190
    v_exp_f32 v191, v191
    v_pk_add_f32 v[184:185], v[184:185], 1.0 op_sel_hi:[1,0]
    v_pk_add_f32 v[186:187], v[186:187], 1.0 op_sel_hi:[1,0]
    v_pk_add_f32 v[188:189], v[188:189], 1.0 op_sel_hi:[1,0]
    v_pk_add_f32 v[190:191], v[190:191], 1.0 op_sel_hi:[1,0]
    v_rcp_f32 v184, v184
    v_rcp_f32 v185, v185
    v_rcp_f32 v186, v186
    v_rcp_f32 v187, v187
    v_rcp_f32 v188, v188
    v_rcp_f32 v189, v189
    v_rcp_f32 v190, v190
    v_rcp_f32 v191, v191
    v_pk_mul_f32 v[184:185], v[72:73], v[184:185]
    v_pk_mul_f32 v[186:187], v[74:75], v[186:187]
    v_pk_mul_f32 v[188:189], v[76:77], v[188:189]
    v_pk_mul_f32 v[190:191], v[78:79], v[190:191]
    v_cvt_pk_bf16_f32 v196, v184, v185
    v_cvt_pk_bf16_f32 v197, v186, v187
    v_cvt_pk_bf16_f32 v198, v188, v189
    v_cvt_pk_bf16_f32 v199, v190, v191
    buffer_store_dwordx4 v[196:199], v7, s[32:35], s49 offen offset:0 sc1
    v_pk_mul_f32 v[176:177], v[80:81], s[4:5]
    v_pk_mul_f32 v[178:179], v[82:83], s[4:5]
    v_pk_mul_f32 v[180:181], v[84:85], s[4:5]
    v_pk_mul_f32 v[182:183], v[86:87], s[4:5]
    v_exp_f32 v176, v176
    v_exp_f32 v177, v177
    v_exp_f32 v178, v178
    v_exp_f32 v179, v179
    v_exp_f32 v180, v180
    v_exp_f32 v181, v181
    v_exp_f32 v182, v182
    v_exp_f32 v183, v183
    v_pk_add_f32 v[176:177], v[176:177], 1.0 op_sel_hi:[1,0]
    v_pk_add_f32 v[178:179], v[178:179], 1.0 op_sel_hi:[1,0]
    v_pk_add_f32 v[180:181], v[180:181], 1.0 op_sel_hi:[1,0]
    v_pk_add_f32 v[182:183], v[182:183], 1.0 op_sel_hi:[1,0]
    v_rcp_f32 v176, v176
    v_rcp_f32 v177, v177
    v_rcp_f32 v178, v178
    v_rcp_f32 v179, v179
    v_rcp_f32 v180, v180
    v_rcp_f32 v181, v181
    v_rcp_f32 v182, v182
    v_rcp_f32 v183, v183
    v_pk_mul_f32 v[176:177], v[80:81], v[176:177]
    v_pk_mul_f32 v[178:179], v[82:83], v[178:179]
    v_pk_mul_f32 v[180:181], v[84:85], v[180:181]
    v_pk_mul_f32 v[182:183], v[86:87], v[182:183]
    v_cvt_pk_bf16_f32 v200, v176, v177
    v_cvt_pk_bf16_f32 v201, v178, v179
    v_cvt_pk_bf16_f32 v202, v180, v181
    v_cvt_pk_bf16_f32 v203, v182, v183
    buffer_store_dwordx4 v[200:203], v1, s[32:35], s49 offen offset:2048 sc1
    v_pk_mul_f32 v[184:185], v[88:89], s[4:5]
    v_pk_mul_f32 v[186:187], v[90:91], s[4:5]
    v_pk_mul_f32 v[188:189], v[92:93], s[4:5]
    v_pk_mul_f32 v[190:191], v[94:95], s[4:5]
    v_exp_f32 v184, v184
    v_exp_f32 v185, v185
    v_exp_f32 v186, v186
    v_exp_f32 v187, v187
    v_exp_f32 v188, v188
    v_exp_f32 v189, v189
    v_exp_f32 v190, v190
    v_exp_f32 v191, v191
    v_pk_add_f32 v[184:185], v[184:185], 1.0 op_sel_hi:[1,0]
    v_pk_add_f32 v[186:187], v[186:187], 1.0 op_sel_hi:[1,0]
    v_pk_add_f32 v[188:189], v[188:189], 1.0 op_sel_hi:[1,0]
    v_pk_add_f32 v[190:191], v[190:191], 1.0 op_sel_hi:[1,0]
    v_rcp_f32 v184, v184
    v_rcp_f32 v185, v185
    v_rcp_f32 v186, v186
    v_rcp_f32 v187, v187
    v_rcp_f32 v188, v188
    v_rcp_f32 v189, v189
    v_rcp_f32 v190, v190
    v_rcp_f32 v191, v191
    v_pk_mul_f32 v[184:185], v[88:89], v[184:185]
    v_pk_mul_f32 v[186:187], v[90:91], v[186:187]
    v_pk_mul_f32 v[188:189], v[92:93], v[188:189]
    v_pk_mul_f32 v[190:191], v[94:95], v[190:191]
    v_cvt_pk_bf16_f32 v204, v184, v185
    v_cvt_pk_bf16_f32 v205, v186, v187
    v_cvt_pk_bf16_f32 v206, v188, v189
    v_cvt_pk_bf16_f32 v207, v190, v191
    buffer_store_dwordx4 v[204:207], v7, s[32:35], s49 offen offset:2048 sc1
    v_pk_mul_f32 v[176:177], v[96:97], s[4:5]
    v_pk_mul_f32 v[178:179], v[98:99], s[4:5]
    v_pk_mul_f32 v[180:181], v[100:101], s[4:5]
    v_pk_mul_f32 v[182:183], v[102:103], s[4:5]
    v_exp_f32 v176, v176
    v_exp_f32 v177, v177
    v_exp_f32 v178, v178
    v_exp_f32 v179, v179
    v_exp_f32 v180, v180
    v_exp_f32 v181, v181
    v_exp_f32 v182, v182
    v_exp_f32 v183, v183
    v_pk_add_f32 v[176:177], v[176:177], 1.0 op_sel_hi:[1,0]
    v_pk_add_f32 v[178:179], v[178:179], 1.0 op_sel_hi:[1,0]
    v_pk_add_f32 v[180:181], v[180:181], 1.0 op_sel_hi:[1,0]
    v_pk_add_f32 v[182:183], v[182:183], 1.0 op_sel_hi:[1,0]
    v_rcp_f32 v176, v176
    v_rcp_f32 v177, v177
    v_rcp_f32 v178, v178
    v_rcp_f32 v179, v179
    v_rcp_f32 v180, v180
    v_rcp_f32 v181, v181
    v_rcp_f32 v182, v182
    v_rcp_f32 v183, v183
    v_pk_mul_f32 v[176:177], v[96:97], v[176:177]
    v_pk_mul_f32 v[178:179], v[98:99], v[178:179]
    v_pk_mul_f32 v[180:181], v[100:101], v[180:181]
    v_pk_mul_f32 v[182:183], v[102:103], v[182:183]
    v_cvt_pk_bf16_f32 v208, v176, v177
    v_cvt_pk_bf16_f32 v209, v178, v179
    v_cvt_pk_bf16_f32 v210, v180, v181
    v_cvt_pk_bf16_f32 v211, v182, v183
    buffer_store_dwordx4 v[208:211], v1, s[32:35], s50 offen offset:0 sc1
    v_pk_mul_f32 v[184:185], v[104:105], s[4:5]
    v_pk_mul_f32 v[186:187], v[106:107], s[4:5]
    v_pk_mul_f32 v[188:189], v[108:109], s[4:5]
    v_pk_mul_f32 v[190:191], v[110:111], s[4:5]
    v_exp_f32 v184, v184
    v_exp_f32 v185, v185
    v_exp_f32 v186, v186
    v_exp_f32 v187, v187
    v_exp_f32 v188, v188
    v_exp_f32 v189, v189
    v_exp_f32 v190, v190
    v_exp_f32 v191, v191
    v_pk_add_f32 v[184:185], v[184:185], 1.0 op_sel_hi:[1,0]
    v_pk_add_f32 v[186:187], v[186:187], 1.0 op_sel_hi:[1,0]
    v_pk_add_f32 v[188:189], v[188:189], 1.0 op_sel_hi:[1,0]
    v_pk_add_f32 v[190:191], v[190:191], 1.0 op_sel_hi:[1,0]
    v_rcp_f32 v184, v184
    v_rcp_f32 v185, v185
    v_rcp_f32 v186, v186
    v_rcp_f32 v187, v187
    v_rcp_f32 v188, v188
    v_rcp_f32 v189, v189
    v_rcp_f32 v190, v190
    v_rcp_f32 v191, v191
    v_pk_mul_f32 v[184:185], v[104:105], v[184:185]
    v_pk_mul_f32 v[186:187], v[106:107], v[186:187]
    v_pk_mul_f32 v[188:189], v[108:109], v[188:189]
    v_pk_mul_f32 v[190:191], v[110:111], v[190:191]
    v_cvt_pk_bf16_f32 v212, v184, v185
    v_cvt_pk_bf16_f32 v213, v186, v187
    v_cvt_pk_bf16_f32 v214, v188, v189
    v_cvt_pk_bf16_f32 v215, v190, v191
    buffer_store_dwordx4 v[212:215], v7, s[32:35], s50 offen offset:0 sc1
    s_mov_b32 s45, 6356992
    buffer_load_dword v8, v6, s[32:35], s45 offen sc1
    s_mul_i32 s58, s64, 40
    s_add_u32 m0, s44, 32768
    s_add_u32 s58, s58, s53
    buffer_load_dwordx4 v56, s[24:27], s58 offen offset:0  lds
    s_waitcnt vmcnt(20)
    ds_read_b64_tr_b16 a[0:1], v60 offset:0
    ds_read_b64_tr_b16 a[2:3], v60 offset:1024
    ds_read_b64_tr_b16 a[4:5], v61 offset:0
    ds_read_b64_tr_b16 a[6:7], v61 offset:1024
    buffer_load_dwordx4 v57, s[24:27], s58 offen offset:1024  lds
    ds_read_b64_tr_b16 a[8:9], v62 offset:0
    ds_read_b64_tr_b16 a[10:11], v62 offset:1024
    buffer_load_dwordx4 v58, s[24:27], s58 offen offset:2048  lds
    ds_read_b64_tr_b16 a[12:13], v63 offset:0
    ds_read_b64_tr_b16 a[14:15], v63 offset:1024
    buffer_load_dwordx4 v59, s[24:27], s58 offen offset:3072  lds
    s_waitcnt vmcnt(19)
    s_waitcnt lgkmcnt(7)
    ds_read_b64_tr_b16 a[20:21], v60 offset:4096
    ds_read_b64_tr_b16 a[22:23], v60 offset:5120
    ds_read_b64_tr_b16 a[24:25], v61 offset:4096
    ds_read_b64_tr_b16 a[26:27], v61 offset:5120
    s_mul_i32 s58, s65, 40
    s_add_u32 m0, s44, 36864
    s_add_u32 s58, s58, s53
    buffer_load_dwordx4 v56, s[24:27], s58 offen offset:0  lds
    ds_read_b64_tr_b16 a[28:29], v62 offset:4096
    ds_read_b64_tr_b16 a[30:31], v62 offset:5120
    buffer_load_dwordx4 v57, s[24:27], s58 offen offset:1024  lds
    ds_read_b64_tr_b16 a[32:33], v63 offset:4096
    ds_read_b64_tr_b16 a[34:35], v63 offset:5120
    buffer_load_dwordx4 v58, s[24:27], s58 offen offset:2048  lds
    s_waitcnt vmcnt(18)
    s_waitcnt lgkmcnt(7)
    ds_read_b64_tr_b16 a[40:41], v60 offset:32768
    ds_read_b64_tr_b16 a[42:43], v60 offset:33792
    ds_read_b64_tr_b16 a[44:45], v61 offset:32768
    ds_read_b64_tr_b16 a[46:47], v61 offset:33792
    buffer_load_dwordx4 v59, s[24:27], s58 offen offset:3072  lds
    ds_read_b64_tr_b16 a[48:49], v62 offset:32768
    ds_read_b64_tr_b16 a[50:51], v62 offset:33792
    s_mul_i32 s58, s66, 40
    s_add_u32 m0, s44, 65536
    s_add_u32 s58, s58, s53
    buffer_load_dwordx4 v56, s[24:27], s58 offen offset:0  lds
    ds_read_b64_tr_b16 a[52:53], v63 offset:32768
    ds_read_b64_tr_b16 a[54:55], v63 offset:33792
    buffer_load_dwordx4 v57, s[24:27], s58 offen offset:1024  lds
    s_waitcnt vmcnt(17)
    s_waitcnt lgkmcnt(7)
    ds_read_b64_tr_b16 a[60:61], v60 offset:36864
    ds_read_b64_tr_b16 a[62:63], v60 offset:37888
    ds_read_b64_tr_b16 a[64:65], v61 offset:36864
    ds_read_b64_tr_b16 a[66:67], v61 offset:37888
    buffer_load_dwordx4 v58, s[24:27], s58 offen offset:2048  lds
    ds_read_b64_tr_b16 a[68:69], v62 offset:36864
    ds_read_b64_tr_b16 a[70:71], v62 offset:37888
    buffer_load_dwordx4 v59, s[24:27], s58 offen offset:3072  lds
    ds_read_b64_tr_b16 a[72:73], v63 offset:36864
    ds_read_b64_tr_b16 a[74:75], v63 offset:37888
    s_waitcnt vmcnt(13)
    s_cmp_eq_u32 s36, 0
    s_cselect_b32 s51, s51, 8388608
    s_barrier
    v_mov_b32 v17, s48
    s_mov_b32 exec_hi, 0
    buffer_store_dword v17, v9, s[32:35], s51 offen sc1
    s_mov_b64 exec, -1
    s_barrier
    s_mul_i32 s58, s67, 40
    s_add_u32 m0, s44, 69632
    s_add_u32 s58, s58, s53
    buffer_load_dwordx4 v56, s[24:27], s58 offen offset:0  lds
    buffer_load_dwordx4 v57, s[24:27], s58 offen offset:1024  lds
    buffer_load_dwordx4 v58, s[24:27], s58 offen offset:2048  lds
    buffer_load_dwordx4 v59, s[24:27], s58 offen offset:3072  lds
    s_mul_i32 s58, s68, 40
    s_add_u32 m0, s44, 98304
    s_add_u32 s58, s58, s53
    buffer_load_dwordx4 v56, s[24:27], s58 offen offset:0  lds
    buffer_load_dwordx4 v57, s[24:27], s58 offen offset:1024  lds
    buffer_load_dwordx4 v58, s[24:27], s58 offen offset:2048  lds
    buffer_load_dwordx4 v59, s[24:27], s58 offen offset:3072  lds
    s_waitcnt vmcnt(17)
    v_add_u32 v60, -65536, v60
    v_add_u32 v61, -65536, v61
    v_add_u32 v62, -65536, v62
    v_add_u32 v63, -65536, v63
    s_waitcnt lgkmcnt(7)
    ds_read_b64_tr_b16 a[80:81], v60 offset:0
    ds_read_b64_tr_b16 a[82:83], v60 offset:1024
    ds_read_b64_tr_b16 a[84:85], v61 offset:0
    ds_read_b64_tr_b16 a[86:87], v61 offset:1024
    ds_read_b64_tr_b16 a[88:89], v62 offset:0
    ds_read_b64_tr_b16 a[90:91], v62 offset:1024
    ds_read_b64_tr_b16 a[92:93], v63 offset:0
    ds_read_b64_tr_b16 a[94:95], v63 offset:1024
    s_mul_i32 s58, s69, 40
    s_add_u32 m0, s44, 102400
    s_add_u32 s58, s58, s53
    buffer_load_dwordx4 v56, s[24:27], s58 offen offset:0  lds
    buffer_load_dwordx4 v57, s[24:27], s58 offen offset:1024  lds
    buffer_load_dwordx4 v58, s[24:27], s58 offen offset:2048  lds
    buffer_load_dwordx4 v59, s[24:27], s58 offen offset:3072  lds
    s_mul_i32 s58, s70, 40
    s_add_u32 m0, s44, 131072
    s_add_u32 s58, s58, s53
    buffer_load_dwordx4 v56, s[24:27], s58 offen offset:0  lds
    buffer_load_dwordx4 v57, s[24:27], s58 offen offset:1024  lds
    buffer_load_dwordx4 v58, s[24:27], s58 offen offset:2048  lds
    buffer_load_dwordx4 v59, s[24:27], s58 offen offset:3072  lds
    s_waitcnt vmcnt(21)
    s_waitcnt lgkmcnt(7)
    ds_read_b64_tr_b16 a[100:101], v60 offset:4096
    ds_read_b64_tr_b16 a[102:103], v60 offset:5120
    ds_read_b64_tr_b16 a[104:105], v61 offset:4096
    ds_read_b64_tr_b16 a[106:107], v61 offset:5120
    ds_read_b64_tr_b16 a[108:109], v62 offset:4096
    ds_read_b64_tr_b16 a[110:111], v62 offset:5120
    ds_read_b64_tr_b16 a[112:113], v63 offset:4096
    ds_read_b64_tr_b16 a[114:115], v63 offset:5120
    s_mul_i32 s58, s71, 40
    s_add_u32 m0, s44, 135168
    s_add_u32 s58, s58, s53
    buffer_load_dwordx4 v56, s[24:27], s58 offen offset:0  lds
    buffer_load_dwordx4 v57, s[24:27], s58 offen offset:1024  lds
    buffer_load_dwordx4 v58, s[24:27], s58 offen offset:2048  lds
    buffer_load_dwordx4 v59, s[24:27], s58 offen offset:3072  lds
    s_mov_b32 s15, 20000
L_rp:
    v_cmp_ne_u32 vcc, s48, v8
    s_cmp_eq_u64 vcc, 0
    s_cbranch_scc1 L_rp_go
    s_sub_u32 s15, s15, 1
    s_cmp_eq_u32 s15, 0
    s_cbranch_scc1 L_rp_go
    s_mov_b32 s45, 6356992
    buffer_load_dword v8, v6, s[32:35], s45 offen sc1
    s_waitcnt vmcnt(0)
    s_branch L_rp
L_rp_go:
    s_lshl3_add_u32 s46, s60, s6
    buffer_load_dwordx4 a[16:19], v1, s[32:35], s46 offen sc1
    s_lshl3_add_u32 s46, s61, s6
    buffer_load_dwordx4 a[36:39], v1, s[32:35], s46 offen sc1
    s_lshl3_add_u32 s46, s62, s6
    buffer_load_dwordx4 a[56:59], v1, s[32:35], s46 offen sc1
    s_lshl3_add_u32 s46, s63, s6
    buffer_load_dwordx4 a[76:79], v1, s[32:35], s46 offen sc1
    buffer_load_dword v8, v19, s[32:35], s52 offen sc1
    s_lshl3_add_u32 s46, s64, s6
    buffer_load_dwordx4 a[96:99], v1, s[32:35], s46 offen sc1
    s_lshl3_add_u32 s46, s65, s6
    buffer_load_dwordx4 a[116:119], v1, s[32:35], s46 offen sc1
    s_lshl3_add_u32 s46, s66, s6
    buffer_load_dwordx4 a[136:139], v1, s[32:35], s46 offen sc1
    s_lshl3_add_u32 s46, s67, s6
    buffer_load_dwordx4 a[156:159], v1, s[32:35], s46 offen sc1
    s_lshl3_add_u32 s46, s68, s6
    buffer_load_dwordx4 a[176:179], v1, s[32:35], s46 offen sc1
    s_lshl3_add_u32 s46, s69, s6
    buffer_load_dwordx4 a[196:199], v1, s[32:35], s46 offen sc1
    s_lshl3_add_u32 s46, s70, s6
    buffer_load_dwordx4 a[216:219], v1, s[32:35], s46 offen sc1
    s_lshl3_add_u32 s46, s71, s6
    buffer_load_dwordx4 a[236:239], v1, s[32:35], s46 offen sc1
    s_branch L_hid
L_hp_s:
    s_mov_b32 s15, 20000
L_hp:
    buffer_load_dword v8, v19, s[32:35], s52 offen sc1
    s_sub_u32 s15, s15, 1
    s_waitcnt vmcnt(0)
    v_cmp_ne_u32 vcc, s48, v8
    s_cbranch_scc1 L_hp_go
    s_cbranch_vccnz L_hp
    s_branch L_hp_go
L_ac_c:
    s_mov_b32 s46, 6291456
    v_cmp_ne_u32 vcc, s48, v22
    s_cmp_eq_u64 vcc, 0
    s_cbranch_scc1 L_ac_go
L_ac_s:
    s_mov_b32 s15, 20000
L_ac:
    buffer_load_dword v22, v23, s[32:35], s46 offen sc1
    s_sub_u32 s15, s15, 1
    s_waitcnt vmcnt(0)
    v_cmp_ne_u32 vcc, s48, v22
    s_cbranch_scc1 L_ac_go
    s_cbranch_vccnz L_ac
    s_branch L_ac_go
    .p2align 12
L_hid:
L_w3:
    s_cbranch_execz L_wr
    s_waitcnt vmcnt(8)
    v_cmp_ne_u32 vcc, s48, v8
    s_cbranch_vccnz L_hp_s
L_hp_go:
    s_cmp_eq_u32 s2, 0
    s_cselect_b32 s45, 6291456, s34
    buffer_load_dword v22, v23, s[32:35], s45 offen sc1
    buffer_load_dwordx4 v[64:67], v13, s[32:35], s60 offen sc1
    s_waitcnt lgkmcnt(7)
    ds_read_b64_tr_b16 a[120:121], v60 offset:32768
    ds_read_b64_tr_b16 a[122:123], v60 offset:33792
    ds_read_b64_tr_b16 a[124:125], v61 offset:32768
    ds_read_b64_tr_b16 a[126:127], v61 offset:33792
    ds_read_b64_tr_b16 a[128:129], v62 offset:32768
    ds_read_b64_tr_b16 a[130:131], v62 offset:33792
    buffer_load_dwordx4 v[68:71], v13, s[32:35], s61 offen sc1
    ds_read_b64_tr_b16 a[132:133], v63 offset:32768
    ds_read_b64_tr_b16 a[134:135], v63 offset:33792
    s_waitcnt lgkmcnt(7)
    ds_read_b64_tr_b16 a[140:141], v60 offset:36864
    ds_read_b64_tr_b16 a[142:143], v60 offset:37888
    ds_read_b64_tr_b16 a[144:145], v61 offset:36864
    ds_read_b64_tr_b16 a[146:147], v61 offset:37888
    buffer_load_dwordx4 v[72:75], v13, s[32:35], s62 offen sc1
    ds_read_b64_tr_b16 a[148:149], v62 offset:36864
    ds_read_b64_tr_b16 a[150:151], v62 offset:37888
    ds_read_b64_tr_b16 a[152:153], v63 offset:36864
    ds_read_b64_tr_b16 a[154:155], v63 offset:37888
    v_add_u32 v60, 65536, v60
    v_add_u32 v61, 65536, v61
    v_add_u32 v62, 65536, v62
    v_add_u32 v63, 65536, v63
    s_waitcnt lgkmcnt(7)
    ds_read_b64_tr_b16 a[160:161], v60 offset:0
    ds_read_b64_tr_b16 a[162:163], v60 offset:1024
    buffer_load_dwordx4 v[76:79], v13, s[32:35], s63 offen sc1
    ds_read_b64_tr_b16 a[164:165], v61 offset:0
    ds_read_b64_tr_b16 a[166:167], v61 offset:1024
    ds_read_b64_tr_b16 a[168:169], v62 offset:0
    ds_read_b64_tr_b16 a[170:171], v62 offset:1024
    ds_read_b64_tr_b16 a[172:173], v63 offset:0
    ds_read_b64_tr_b16 a[174:175], v63 offset:1024
    buffer_load_dwordx4 v[80:83], v13, s[32:35], s64 offen sc1
    s_waitcnt lgkmcnt(7)
    ds_read_b64_tr_b16 a[180:181], v60 offset:4096
    ds_read_b64_tr_b16 a[182:183], v60 offset:5120
    ds_read_b64_tr_b16 a[184:185], v61 offset:4096
    ds_read_b64_tr_b16 a[186:187], v61 offset:5120
    ds_read_b64_tr_b16 a[188:189], v62 offset:4096
    ds_read_b64_tr_b16 a[190:191], v62 offset:5120
    buffer_load_dwordx4 v[84:87], v13, s[32:35], s65 offen sc1
    ds_read_b64_tr_b16 a[192:193], v63 offset:4096
    ds_read_b64_tr_b16 a[194:195], v63 offset:5120
    s_waitcnt lgkmcnt(7)
    ds_read_b64_tr_b16 a[200:201], v60 offset:32768
    ds_read_b64_tr_b16 a[202:203], v60 offset:33792
    ds_read_b64_tr_b16 a[204:205], v61 offset:32768
    ds_read_b64_tr_b16 a[206:207], v61 offset:33792
    buffer_load_dwordx4 v[88:91], v13, s[32:35], s66 offen sc1
    ds_read_b64_tr_b16 a[208:209], v62 offset:32768
    ds_read_b64_tr_b16 a[210:211], v62 offset:33792
    ds_read_b64_tr_b16 a[212:213], v63 offset:32768
    ds_read_b64_tr_b16 a[214:215], v63 offset:33792
    s_waitcnt lgkmcnt(7)
    ds_read_b64_tr_b16 a[220:221], v60 offset:36864
    ds_read_b64_tr_b16 a[222:223], v60 offset:37888
    buffer_load_dwordx4 v[92:95], v13, s[32:35], s67 offen sc1
    ds_read_b64_tr_b16 a[224:225], v61 offset:36864
    ds_read_b64_tr_b16 a[226:227], v61 offset:37888
    ds_read_b64_tr_b16 a[228:229], v62 offset:36864
    ds_read_b64_tr_b16 a[230:231], v62 offset:37888
    ds_read_b64_tr_b16 a[232:233], v63 offset:36864
    ds_read_b64_tr_b16 a[234:235], v63 offset:37888
    s_waitcnt lgkmcnt(0)
    s_waitcnt vmcnt(7)
    v_mfma_f32_16x16x32_bf16 v[24:27], a[0:3], v[64:67], 0
    v_mfma_f32_16x16x32_bf16 v[28:31], a[4:7], v[64:67], 0
    buffer_load_dwordx4 v[96:99], v13, s[32:35], s68 offen sc1
    v_mfma_f32_16x16x32_bf16 v[32:35], a[8:11], v[64:67], 0
    v_mfma_f32_16x16x32_bf16 v[36:39], a[12:15], v[64:67], 0
    v_mfma_f32_16x16x32_bf16 v[40:43], v[64:67], a[16:19], 0
    s_waitcnt vmcnt(7)
    v_mfma_f32_16x16x32_bf16 v[24:27], a[20:23], v[68:71], v[24:27]
    v_mfma_f32_16x16x32_bf16 v[28:31], a[24:27], v[68:71], v[28:31]
    buffer_load_dwordx4 v[100:103], v13, s[32:35], s69 offen sc1
    v_mfma_f32_16x16x32_bf16 v[32:35], a[28:31], v[68:71], v[32:35]
    v_mfma_f32_16x16x32_bf16 v[36:39], a[32:35], v[68:71], v[36:39]
    v_mfma_f32_16x16x32_bf16 v[40:43], v[68:71], a[36:39], v[40:43]
    s_waitcnt vmcnt(7)
    v_mfma_f32_16x16x32_bf16 v[24:27], a[40:43], v[72:75], v[24:27]
    v_mfma_f32_16x16x32_bf16 v[28:31], a[44:47], v[72:75], v[28:31]
    buffer_load_dwordx4 v[104:107], v13, s[32:35], s70 offen sc1
    v_mfma_f32_16x16x32_bf16 v[32:35], a[48:51], v[72:75], v[32:35]
    v_mfma_f32_16x16x32_bf16 v[36:39], a[52:55], v[72:75], v[36:39]
    v_mfma_f32_16x16x32_bf16 v[40:43], v[72:75], a[56:59], v[40:43]
    s_waitcnt vmcnt(7)
    v_mfma_f32_16x16x32_bf16 v[24:27], a[60:63], v[76:79], v[24:27]
    v_mfma_f32_16x16x32_bf16 v[28:31], a[64:67], v[76:79], v[28:31]
    buffer_load_dwordx4 v[108:111], v13, s[32:35], s71 offen sc1
    v_mfma_f32_16x16x32_bf16 v[32:35], a[68:71], v[76:79], v[32:35]
    v_mfma_f32_16x16x32_bf16 v[36:39], a[72:75], v[76:79], v[36:39]
    v_mfma_f32_16x16x32_bf16 v[40:43], v[76:79], a[76:79], v[40:43]
    s_waitcnt vmcnt(7)
    v_mfma_f32_16x16x32_bf16 v[24:27], a[80:83], v[80:83], v[24:27]
    v_mfma_f32_16x16x32_bf16 v[28:31], a[84:87], v[80:83], v[28:31]
    buffer_load_dwordx4 v[112:115], v14, s[32:35], s60 offen sc1
    v_mfma_f32_16x16x32_bf16 v[32:35], a[88:91], v[80:83], v[32:35]
    v_mfma_f32_16x16x32_bf16 v[36:39], a[92:95], v[80:83], v[36:39]
    v_mfma_f32_16x16x32_bf16 v[40:43], v[80:83], a[96:99], v[40:43]
    s_waitcnt vmcnt(7)
    v_mfma_f32_16x16x32_bf16 v[24:27], a[100:103], v[84:87], v[24:27]
    v_mfma_f32_16x16x32_bf16 v[28:31], a[104:107], v[84:87], v[28:31]
    buffer_load_dwordx4 v[116:119], v14, s[32:35], s61 offen sc1
    v_mfma_f32_16x16x32_bf16 v[32:35], a[108:111], v[84:87], v[32:35]
    v_mfma_f32_16x16x32_bf16 v[36:39], a[112:115], v[84:87], v[36:39]
    v_mfma_f32_16x16x32_bf16 v[40:43], v[84:87], a[116:119], v[40:43]
    s_waitcnt vmcnt(7)
    v_mfma_f32_16x16x32_bf16 v[24:27], a[120:123], v[88:91], v[24:27]
    v_mfma_f32_16x16x32_bf16 v[28:31], a[124:127], v[88:91], v[28:31]
    buffer_load_dwordx4 v[120:123], v14, s[32:35], s62 offen sc1
    v_mfma_f32_16x16x32_bf16 v[32:35], a[128:131], v[88:91], v[32:35]
    v_mfma_f32_16x16x32_bf16 v[36:39], a[132:135], v[88:91], v[36:39]
    v_mfma_f32_16x16x32_bf16 v[40:43], v[88:91], a[136:139], v[40:43]
    s_waitcnt vmcnt(7)
    v_mfma_f32_16x16x32_bf16 v[24:27], a[140:143], v[92:95], v[24:27]
    v_mfma_f32_16x16x32_bf16 v[28:31], a[144:147], v[92:95], v[28:31]
    buffer_load_dwordx4 v[124:127], v14, s[32:35], s63 offen sc1
    v_mfma_f32_16x16x32_bf16 v[32:35], a[148:151], v[92:95], v[32:35]
    v_mfma_f32_16x16x32_bf16 v[36:39], a[152:155], v[92:95], v[36:39]
    v_mfma_f32_16x16x32_bf16 v[40:43], v[92:95], a[156:159], v[40:43]
    s_waitcnt vmcnt(7)
    v_mfma_f32_16x16x32_bf16 v[24:27], a[160:163], v[96:99], v[24:27]
    v_mfma_f32_16x16x32_bf16 v[28:31], a[164:167], v[96:99], v[28:31]
    buffer_load_dwordx4 v[128:131], v14, s[32:35], s64 offen sc1
    v_mfma_f32_16x16x32_bf16 v[32:35], a[168:171], v[96:99], v[32:35]
    v_mfma_f32_16x16x32_bf16 v[36:39], a[172:175], v[96:99], v[36:39]
    v_mfma_f32_16x16x32_bf16 v[40:43], v[96:99], a[176:179], v[40:43]
    s_waitcnt vmcnt(7)
    v_mfma_f32_16x16x32_bf16 v[24:27], a[180:183], v[100:103], v[24:27]
    v_mfma_f32_16x16x32_bf16 v[28:31], a[184:187], v[100:103], v[28:31]
    buffer_load_dwordx4 v[132:135], v14, s[32:35], s65 offen sc1
    v_mfma_f32_16x16x32_bf16 v[32:35], a[188:191], v[100:103], v[32:35]
    v_mfma_f32_16x16x32_bf16 v[36:39], a[192:195], v[100:103], v[36:39]
    v_mfma_f32_16x16x32_bf16 v[40:43], v[100:103], a[196:199], v[40:43]
    s_waitcnt vmcnt(7)
    v_mfma_f32_16x16x32_bf16 v[24:27], a[200:203], v[104:107], v[24:27]
    v_mfma_f32_16x16x32_bf16 v[28:31], a[204:207], v[104:107], v[28:31]
    buffer_load_dwordx4 v[136:139], v14, s[32:35], s66 offen sc1
    v_mfma_f32_16x16x32_bf16 v[32:35], a[208:211], v[104:107], v[32:35]
    v_mfma_f32_16x16x32_bf16 v[36:39], a[212:215], v[104:107], v[36:39]
    v_mfma_f32_16x16x32_bf16 v[40:43], v[104:107], a[216:219], v[40:43]
    s_waitcnt vmcnt(7)
    v_mfma_f32_16x16x32_bf16 v[24:27], a[220:223], v[108:111], v[24:27]
    v_mfma_f32_16x16x32_bf16 v[28:31], a[224:227], v[108:111], v[28:31]
    buffer_load_dwordx4 v[140:143], v14, s[32:35], s67 offen sc1
    v_mfma_f32_16x16x32_bf16 v[32:35], a[228:231], v[108:111], v[32:35]
    v_mfma_f32_16x16x32_bf16 v[36:39], a[232:235], v[108:111], v[36:39]
    v_mfma_f32_16x16x32_bf16 v[40:43], v[108:111], a[236:239], v[40:43]
    s_waitcnt vmcnt(7)
    v_mfma_f32_16x16x32_bf16 v[44:47], a[0:3], v[112:115], 0
    v_mfma_f32_16x16x32_bf16 v[48:51], a[4:7], v[112:115], 0
    buffer_load_dwordx4 v[144:147], v14, s[32:35], s68 offen sc1
    v_mfma_f32_16x16x32_bf16 v[52:55], a[8:11], v[112:115], 0
    v_mfma_f32_16x16x32_bf16 v[56:59], a[12:15], v[112:115], 0
    v_mfma_f32_16x16x32_bf16 v[60:63], v[112:115], a[16:19], 0
    s_waitcnt vmcnt(7)
    v_mfma_f32_16x16x32_bf16 v[44:47], a[20:23], v[116:119], v[44:47]
    ds_write_b128 v5, v[24:27] offset:0
    v_mfma_f32_16x16x32_bf16 v[48:51], a[24:27], v[116:119], v[48:51]
    buffer_load_dwordx4 v[148:151], v14, s[32:35], s69 offen sc1
    v_mfma_f32_16x16x32_bf16 v[52:55], a[28:31], v[116:119], v[52:55]
    v_mfma_f32_16x16x32_bf16 v[56:59], a[32:35], v[116:119], v[56:59]
    v_mfma_f32_16x16x32_bf16 v[60:63], v[116:119], a[36:39], v[60:63]
    s_waitcnt vmcnt(7)
    v_mfma_f32_16x16x32_bf16 v[44:47], a[40:43], v[120:123], v[44:47]
    v_mfma_f32_16x16x32_bf16 v[48:51], a[44:47], v[120:123], v[48:51]
    buffer_load_dwordx4 v[152:155], v14, s[32:35], s70 offen sc1
    v_mfma_f32_16x16x32_bf16 v[52:55], a[48:51], v[120:123], v[52:55]
    v_mfma_f32_16x16x32_bf16 v[56:59], a[52:55], v[120:123], v[56:59]
    v_mfma_f32_16x16x32_bf16 v[60:63], v[120:123], a[56:59], v[60:63]
    s_waitcnt vmcnt(7)
    v_mfma_f32_16x16x32_bf16 v[44:47], a[60:63], v[124:127], v[44:47]
    ds_write_b128 v5, v[28:31] offset:1024
    v_mfma_f32_16x16x32_bf16 v[48:51], a[64:67], v[124:127], v[48:51]
    buffer_load_dwordx4 v[156:159], v14, s[32:35], s71 offen sc1
    v_mfma_f32_16x16x32_bf16 v[52:55], a[68:71], v[124:127], v[52:55]
    v_mfma_f32_16x16x32_bf16 v[56:59], a[72:75], v[124:127], v[56:59]
    v_mfma_f32_16x16x32_bf16 v[60:63], v[124:127], a[76:79], v[60:63]
    s_waitcnt vmcnt(7)
    v_mfma_f32_16x16x32_bf16 v[44:47], a[80:83], v[128:131], v[44:47]
    v_mfma_f32_16x16x32_bf16 v[48:51], a[84:87], v[128:131], v[48:51]
    buffer_load_dwordx4 v[160:163], v15, s[32:35], s60 offen sc1
    v_mfma_f32_16x16x32_bf16 v[52:55], a[88:91], v[128:131], v[52:55]
    v_mfma_f32_16x16x32_bf16 v[56:59], a[92:95], v[128:131], v[56:59]
    v_mfma_f32_16x16x32_bf16 v[60:63], v[128:131], a[96:99], v[60:63]
    s_waitcnt vmcnt(7)
    v_mfma_f32_16x16x32_bf16 v[44:47], a[100:103], v[132:135], v[44:47]
    ds_write_b128 v5, v[32:35] offset:2048
    v_mfma_f32_16x16x32_bf16 v[48:51], a[104:107], v[132:135], v[48:51]
    buffer_load_dwordx4 v[164:167], v15, s[32:35], s61 offen sc1
    v_mfma_f32_16x16x32_bf16 v[52:55], a[108:111], v[132:135], v[52:55]
    v_mfma_f32_16x16x32_bf16 v[56:59], a[112:115], v[132:135], v[56:59]
    v_mfma_f32_16x16x32_bf16 v[60:63], v[132:135], a[116:119], v[60:63]
    s_waitcnt vmcnt(7)
    v_mfma_f32_16x16x32_bf16 v[44:47], a[120:123], v[136:139], v[44:47]
    v_mfma_f32_16x16x32_bf16 v[48:51], a[124:127], v[136:139], v[48:51]
    buffer_load_dwordx4 v[168:171], v15, s[32:35], s62 offen sc1
    v_mfma_f32_16x16x32_bf16 v[52:55], a[128:131], v[136:139], v[52:55]
    v_mfma_f32_16x16x32_bf16 v[56:59], a[132:135], v[136:139], v[56:59]
    v_mfma_f32_16x16x32_bf16 v[60:63], v[136:139], a[136:139], v[60:63]
    s_waitcnt vmcnt(7)
    v_mfma_f32_16x16x32_bf16 v[44:47], a[140:143], v[140:143], v[44:47]
    ds_write_b128 v5, v[36:39] offset:3072
    v_mfma_f32_16x16x32_bf16 v[48:51], a[144:147], v[140:143], v[48:51]
    buffer_load_dwordx4 v[172:175], v15, s[32:35], s63 offen sc1
    v_mfma_f32_16x16x32_bf16 v[52:55], a[148:151], v[140:143], v[52:55]
    v_mfma_f32_16x16x32_bf16 v[56:59], a[152:155], v[140:143], v[56:59]
    v_mfma_f32_16x16x32_bf16 v[60:63], v[140:143], a[156:159], v[60:63]
    s_waitcnt vmcnt(7)
    v_mfma_f32_16x16x32_bf16 v[44:47], a[160:163], v[144:147], v[44:47]
    v_mfma_f32_16x16x32_bf16 v[48:51], a[164:167], v[144:147], v[48:51]
    buffer_load_dwordx4 v[176:179], v15, s[32:35], s64 offen sc1
    v_mfma_f32_16x16x32_bf16 v[52:55], a[168:171], v[144:147], v[52:55]
    v_mfma_f32_16x16x32_bf16 v[56:59], a[172:175], v[144:147], v[56:59]
    v_mfma_f32_16x16x32_bf16 v[60:63], v[144:147], a[176:179], v[60:63]
    s_waitcnt vmcnt(7)
    v_mfma_f32_16x16x32_bf16 v[44:47], a[180:183], v[148:151], v[44:47]
    ds_write_b128 v5, v[40:43] offset:4096
    v_mfma_f32_16x16x32_bf16 v[48:51], a[184:187], v[148:151], v[48:51]
    buffer_load_dwordx4 v[180:183], v15, s[32:35], s65 offen sc1
    v_mfma_f32_16x16x32_bf16 v[52:55], a[188:191], v[148:151], v[52:55]
    v_mfma_f32_16x16x32_bf16 v[56:59], a[192:195], v[148:151], v[56:59]
    v_mfma_f32_16x16x32_bf16 v[60:63], v[148:151], a[196:199], v[60:63]
    s_waitcnt vmcnt(7)
    v_mfma_f32_16x16x32_bf16 v[44:47], a[200:203], v[152:155], v[44:47]
    v_mfma_f32_16x16x32_bf16 v[48:51], a[204:207], v[152:155], v[48:51]
    buffer_load_dwordx4 v[184:187], v15, s[32:35], s66 offen sc1
    v_mfma_f32_16x16x32_bf16 v[52:55], a[208:211], v[152:155], v[52:55]
    v_mfma_f32_16x16x32_bf16 v[56:59], a[212:215], v[152:155], v[56:59]
    v_mfma_f32_16x16x32_bf16 v[60:63], v[152:155], a[216:219], v[60:63]
    s_waitcnt vmcnt(7)
    v_mfma_f32_16x16x32_bf16 v[44:47], a[220:223], v[156:159], v[44:47]
    v_mfma_f32_16x16x32_bf16 v[48:51], a[224:227], v[156:159], v[48:51]
    buffer_load_dwordx4 v[188:191], v15, s[32:35], s67 offen sc1
    v_mfma_f32_16x16x32_bf16 v[52:55], a[228:231], v[156:159], v[52:55]
    v_mfma_f32_16x16x32_bf16 v[56:59], a[232:235], v[156:159], v[56:59]
    v_mfma_f32_16x16x32_bf16 v[60:63], v[156:159], a[236:239], v[60:63]
    s_waitcnt vmcnt(7)
    v_mfma_f32_16x16x32_bf16 v[24:27], a[0:3], v[160:163], 0
    v_mfma_f32_16x16x32_bf16 v[28:31], a[4:7], v[160:163], 0
    buffer_load_dwordx4 v[192:195], v15, s[32:35], s68 offen sc1
    v_mfma_f32_16x16x32_bf16 v[32:35], a[8:11], v[160:163], 0
    v_mfma_f32_16x16x32_bf16 v[36:39], a[12:15], v[160:163], 0
    v_mfma_f32_16x16x32_bf16 v[40:43], v[160:163], a[16:19], 0
    s_waitcnt vmcnt(7)
    v_mfma_f32_16x16x32_bf16 v[24:27], a[20:23], v[164:167], v[24:27]
    ds_write_b128 v5, v[44:47] offset:32768
    v_mfma_f32_16x16x32_bf16 v[28:31], a[24:27], v[164:167], v[28:31]
    buffer_load_dwordx4 v[196:199], v15, s[32:35], s69 offen sc1
    v_mfma_f32_16x16x32_bf16 v[32:35], a[28:31], v[164:167], v[32:35]
    v_mfma_f32_16x16x32_bf16 v[36:39], a[32:35], v[164:167], v[36:39]
    v_mfma_f32_16x16x32_bf16 v[40:43], v[164:167], a[36:39], v[40:43]
    s_waitcnt vmcnt(7)
    v_mfma_f32_16x16x32_bf16 v[24:27], a[40:43], v[168:171], v[24:27]
    ds_write_b128 v5, v[48:51] offset:33792
    v_mfma_f32_16x16x32_bf16 v[28:31], a[44:47], v[168:171], v[28:31]
    buffer_load_dwordx4 v[200:203], v15, s[32:35], s70 offen sc1
    v_mfma_f32_16x16x32_bf16 v[32:35], a[48:51], v[168:171], v[32:35]
    v_mfma_f32_16x16x32_bf16 v[36:39], a[52:55], v[168:171], v[36:39]
    v_mfma_f32_16x16x32_bf16 v[40:43], v[168:171], a[56:59], v[40:43]
    s_waitcnt vmcnt(7)
    v_mfma_f32_16x16x32_bf16 v[24:27], a[60:63], v[172:175], v[24:27]
    ds_write_b128 v5, v[52:55] offset:34816
    v_mfma_f32_16x16x32_bf16 v[28:31], a[64:67], v[172:175], v[28:31]
    buffer_load_dwordx4 v[204:207], v15, s[32:35], s71 offen sc1
    v_mfma_f32_16x16x32_bf16 v[32:35], a[68:71], v[172:175], v[32:35]
    v_mfma_f32_16x16x32_bf16 v[36:39], a[72:75], v[172:175], v[36:39]
    v_mfma_f32_16x16x32_bf16 v[40:43], v[172:175], a[76:79], v[40:43]
    s_waitcnt vmcnt(7)
    v_mfma_f32_16x16x32_bf16 v[24:27], a[80:83], v[176:179], v[24:27]
    ds_write_b128 v5, v[56:59] offset:35840
    v_mfma_f32_16x16x32_bf16 v[28:31], a[84:87], v[176:179], v[28:31]
    buffer_load_dwordx4 v[208:211], v16, s[32:35], s60 offen sc1
    v_mfma_f32_16x16x32_bf16 v[32:35], a[88:91], v[176:179], v[32:35]
    v_mfma_f32_16x16x32_bf16 v[36:39], a[92:95], v[176:179], v[36:39]
    v_mfma_f32_16x16x32_bf16 v[40:43], v[176:179], a[96:99], v[40:43]
    s_waitcnt vmcnt(7)
    v_mfma_f32_16x16x32_bf16 v[24:27], a[100:103], v[180:183], v[24:27]
    ds_write_b128 v5, v[60:63] offset:36864
    v_mfma_f32_16x16x32_bf16 v[28:31], a[104:107], v[180:183], v[28:31]
    buffer_load_dwordx4 v[212:215], v16, s[32:35], s61 offen sc1
    v_mfma_f32_16x16x32_bf16 v[32:35], a[108:111], v[180:183], v[32:35]
    v_mfma_f32_16x16x32_bf16 v[36:39], a[112:115], v[180:183], v[36:39]
    v_mfma_f32_16x16x32_bf16 v[40:43], v[180:183], a[116:119], v[40:43]
    s_waitcnt lgkmcnt(0)
    s_barrier
    s_waitcnt vmcnt(7)
    v_mfma_f32_16x16x32_bf16 v[24:27], a[120:123], v[184:187], v[24:27]
    ds_read_b128 v[64:67], v10 offset:0
    v_mfma_f32_16x16x32_bf16 v[28:31], a[124:127], v[184:187], v[28:31]
    buffer_load_dwordx4 v[216:219], v16, s[32:35], s62 offen sc1
    ds_read_b128 v[84:87], v11 offset:0
    v_mfma_f32_16x16x32_bf16 v[32:35], a[128:131], v[184:187], v[32:35]
    ds_read_b128 v[68:71], v10 offset:1024
    v_mfma_f32_16x16x32_bf16 v[36:39], a[132:135], v[184:187], v[36:39]
    ds_read_b128 v[88:91], v11 offset:1024
    v_mfma_f32_16x16x32_bf16 v[40:43], v[184:187], a[136:139], v[40:43]
    ds_read_b128 v[72:75], v10 offset:2048
    s_waitcnt vmcnt(7)
    v_mfma_f32_16x16x32_bf16 v[24:27], a[140:143], v[188:191], v[24:27]
    ds_read_b128 v[92:95], v11 offset:2048
    v_mfma_f32_16x16x32_bf16 v[28:31], a[144:147], v[188:191], v[28:31]
    buffer_load_dwordx4 v[220:223], v16, s[32:35], s63 offen sc1
    ds_read_b128 v[76:79], v10 offset:3072
    v_mfma_f32_16x16x32_bf16 v[32:35], a[148:151], v[188:191], v[32:35]
    ds_read_b128 v[96:99], v11 offset:3072
    v_mfma_f32_16x16x32_bf16 v[36:39], a[152:155], v[188:191], v[36:39]
    ds_read_b128 v[80:83], v10 offset:4096
    v_mfma_f32_16x16x32_bf16 v[40:43], v[188:191], a[156:159], v[40:43]
    ds_read_b128 v[100:103], v11 offset:4096
    s_waitcnt vmcnt(7)
    v_mfma_f32_16x16x32_bf16 v[24:27], a[160:163], v[192:195], v[24:27]
    v_mfma_f32_16x16x32_bf16 v[28:31], a[164:167], v[192:195], v[28:31]
    buffer_load_dwordx4 v[224:227], v16, s[32:35], s64 offen sc1
    v_mfma_f32_16x16x32_bf16 v[32:35], a[168:171], v[192:195], v[32:35]
    v_mfma_f32_16x16x32_bf16 v[36:39], a[172:175], v[192:195], v[36:39]
    v_mfma_f32_16x16x32_bf16 v[40:43], v[192:195], a[176:179], v[40:43]
    s_waitcnt vmcnt(7)
    v_mfma_f32_16x16x32_bf16 v[24:27], a[180:183], v[196:199], v[24:27]
    s_waitcnt lgkmcnt(8)
    v_add_f32 v44, v64, v84
    v_add_f32 v45, v65, v85
    v_mfma_f32_16x16x32_bf16 v[28:31], a[184:187], v[196:199], v[28:31]
    buffer_load_dwordx4 v[228:231], v16, s[32:35], s65 offen sc1
    v_add_f32 v46, v66, v86
    v_mfma_f32_16x16x32_bf16 v[32:35], a[188:191], v[196:199], v[32:35]
    v_add_f32 v47, v67, v87
    v_mfma_f32_16x16x32_bf16 v[36:39], a[192:195], v[196:199], v[36:39]
    s_waitcnt lgkmcnt(6)
    v_add_f32 v48, v68, v88
    v_add_f32 v49, v69, v89
    v_mfma_f32_16x16x32_bf16 v[40:43], v[196:199], a[196:199], v[40:43]
    v_add_f32 v50, v70, v90
    s_waitcnt vmcnt(7)
    v_mfma_f32_16x16x32_bf16 v[24:27], a[200:203], v[200:203], v[24:27]
    v_add_f32 v51, v71, v91
    v_mfma_f32_16x16x32_bf16 v[28:31], a[204:207], v[200:203], v[28:31]
    buffer_load_dwordx4 v[232:235], v16, s[32:35], s66 offen sc1
    s_waitcnt lgkmcnt(4)
    v_add_f32 v52, v72, v92
    v_add_f32 v53, v73, v93
    v_mfma_f32_16x16x32_bf16 v[32:35], a[208:211], v[200:203], v[32:35]
    v_add_f32 v54, v74, v94
    v_mfma_f32_16x16x32_bf16 v[36:39], a[212:215], v[200:203], v[36:39]
    v_add_f32 v55, v75, v95
    v_mfma_f32_16x16x32_bf16 v[40:43], v[200:203], a[216:219], v[40:43]
    s_waitcnt lgkmcnt(2)
    v_add_f32 v56, v76, v96
    v_add_f32 v57, v77, v97
    s_waitcnt vmcnt(7)
    v_mfma_f32_16x16x32_bf16 v[24:27], a[220:223], v[204:207], v[24:27]
    v_add_f32 v58, v78, v98
    v_mfma_f32_16x16x32_bf16 v[28:31], a[224:227], v[204:207], v[28:31]
    buffer_load_dwordx4 v[236:239], v16, s[32:35], s67 offen sc1
    v_add_f32 v59, v79, v99
    v_mfma_f32_16x16x32_bf16 v[32:35], a[228:231], v[204:207], v[32:35]
    s_waitcnt lgkmcnt(0)
    v_add_f32 v60, v80, v100
    v_add_f32 v61, v81, v101
    v_mfma_f32_16x16x32_bf16 v[36:39], a[232:235], v[204:207], v[36:39]
    v_add_f32 v62, v82, v102
    v_mfma_f32_16x16x32_bf16 v[40:43], v[204:207], a[236:239], v[40:43]
    v_add_f32 v63, v83, v103
    s_waitcnt vmcnt(7)
    v_mfma_f32_16x16x32_bf16 v[44:47], a[0:3], v[208:211], v[44:47]
    v_mfma_f32_16x16x32_bf16 v[48:51], a[4:7], v[208:211], v[48:51]
    buffer_load_dwordx4 v[240:243], v16, s[32:35], s68 offen sc1
    v_mfma_f32_16x16x32_bf16 v[52:55], a[8:11], v[208:211], v[52:55]
    v_mfma_f32_16x16x32_bf16 v[56:59], a[12:15], v[208:211], v[56:59]
    v_mfma_f32_16x16x32_bf16 v[60:63], v[208:211], a[16:19], v[60:63]
    s_waitcnt vmcnt(7)
    v_mfma_f32_16x16x32_bf16 v[44:47], a[20:23], v[212:215], v[44:47]
    ds_write_b128 v20, v[24:27] offset:0
    v_mfma_f32_16x16x32_bf16 v[48:51], a[24:27], v[212:215], v[48:51]
    buffer_load_dwordx4 v[244:247], v16, s[32:35], s69 offen sc1
    v_mfma_f32_16x16x32_bf16 v[52:55], a[28:31], v[212:215], v[52:55]
    v_mfma_f32_16x16x32_bf16 v[56:59], a[32:35], v[212:215], v[56:59]
    v_mfma_f32_16x16x32_bf16 v[60:63], v[212:215], a[36:39], v[60:63]
    s_waitcnt vmcnt(7)
    v_mfma_f32_16x16x32_bf16 v[44:47], a[40:43], v[216:219], v[44:47]
    ds_write_b128 v20, v[28:31] offset:1024
    v_mfma_f32_16x16x32_bf16 v[48:51], a[44:47], v[216:219], v[48:51]
    buffer_load_dwordx4 v[248:251], v16, s[32:35], s70 offen sc1
    v_mfma_f32_16x16x32_bf16 v[52:55], a[48:51], v[216:219], v[52:55]
    v_mfma_f32_16x16x32_bf16 v[56:59], a[52:55], v[216:219], v[56:59]
    v_mfma_f32_16x16x32_bf16 v[60:63], v[216:219], a[56:59], v[60:63]
    s_waitcnt vmcnt(7)
    v_mfma_f32_16x16x32_bf16 v[44:47], a[60:63], v[220:223], v[44:47]
    ds_write_b128 v20, v[32:35] offset:2048
    v_mfma_f32_16x16x32_bf16 v[48:51], a[64:67], v[220:223], v[48:51]
    buffer_load_dwordx4 v[252:255], v16, s[32:35], s71 offen sc1
    v_mfma_f32_16x16x32_bf16 v[52:55], a[68:71], v[220:223], v[52:55]
    v_mfma_f32_16x16x32_bf16 v[56:59], a[72:75], v[220:223], v[56:59]
    v_mfma_f32_16x16x32_bf16 v[60:63], v[220:223], a[76:79], v[60:63]
    s_waitcnt vmcnt(7)
    v_mfma_f32_16x16x32_bf16 v[44:47], a[80:83], v[224:227], v[44:47]
    ds_write_b128 v20, v[36:39] offset:3072
    v_mfma_f32_16x16x32_bf16 v[48:51], a[84:87], v[224:227], v[48:51]
    v_mfma_f32_16x16x32_bf16 v[52:55], a[88:91], v[224:227], v[52:55]
    v_mfma_f32_16x16x32_bf16 v[56:59], a[92:95], v[224:227], v[56:59]
    s_waitcnt vmcnt(6)
    v_mfma_f32_16x16x32_bf16 v[44:47], a[100:103], v[228:231], v[44:47]
    ds_write_b128 v20, v[40:43] offset:4096
    v_mfma_f32_16x16x32_bf16 v[48:51], a[104:107], v[228:231], v[48:51]
    v_mfma_f32_16x16x32_bf16 v[52:55], a[108:111], v[228:231], v[52:55]
    v_mfma_f32_16x16x32_bf16 v[56:59], a[112:115], v[228:231], v[56:59]
    s_cmp_eq_u32 s2, 0
    s_cbranch_scc1 L_ac_c
L_ac_go:
    s_waitcnt lgkmcnt(0)
    s_barrier
    s_waitcnt vmcnt(5)
    v_mfma_f32_16x16x32_bf16 v[44:47], a[120:123], v[232:235], v[44:47]
    ds_read_b128 v[64:67], v12 offset:0
    v_mfma_f32_16x16x32_bf16 v[48:51], a[124:127], v[232:235], v[48:51]
    ds_read_b128 v[68:71], v12 offset:1024
    v_mfma_f32_16x16x32_bf16 v[52:55], a[128:131], v[232:235], v[52:55]
    ds_read_b128 v[72:75], v12 offset:2048
    v_mfma_f32_16x16x32_bf16 v[56:59], a[132:135], v[232:235], v[56:59]
    ds_read_b128 v[76:79], v12 offset:3072
    ds_read_b128 v[80:83], v12 offset:4096
    s_waitcnt vmcnt(4)
    v_mfma_f32_16x16x32_bf16 v[44:47], a[140:143], v[236:239], v[44:47]
    v_mfma_f32_16x16x32_bf16 v[48:51], a[144:147], v[236:239], v[48:51]
    v_mfma_f32_16x16x32_bf16 v[52:55], a[148:151], v[236:239], v[52:55]
    v_mfma_f32_16x16x32_bf16 v[56:59], a[152:155], v[236:239], v[56:59]
    s_waitcnt vmcnt(3)
    v_mfma_f32_16x16x32_bf16 v[44:47], a[160:163], v[240:243], v[44:47]
    s_waitcnt lgkmcnt(0)
    v_add_f32 v60, v60, v80
    v_add_f32 v61, v61, v81
    v_mfma_f32_16x16x32_bf16 v[48:51], a[164:167], v[240:243], v[48:51]
    v_add_f32 v62, v62, v82
    v_add_f32 v63, v63, v83
    s_waitcnt vmcnt(2)
    v_mfma_f32_16x16x32_bf16 v[44:47], a[180:183], v[244:247], v[44:47]
    v_add_f32 v52, v52, v72
    v_add_f32 v53, v53, v73
    v_mfma_f32_16x16x32_bf16 v[48:51], a[184:187], v[244:247], v[48:51]
    v_add_f32 v54, v54, v74
    v_add_f32 v55, v55, v75
    s_waitcnt vmcnt(1)
    v_mfma_f32_16x16x32_bf16 v[44:47], a[200:203], v[248:251], v[44:47]
    v_add_f32 v56, v56, v76
    v_add_f32 v57, v57, v77
    v_mfma_f32_16x16x32_bf16 v[48:51], a[204:207], v[248:251], v[48:51]
    v_add_f32 v58, v58, v78
    v_add_f32 v59, v59, v79
    s_waitcnt vmcnt(0)
    v_mfma_f32_16x16x32_bf16 v[44:47], a[220:223], v[252:255], v[44:47]
    v_mfma_f32_16x16x32_bf16 v[48:51], a[224:227], v[252:255], v[48:51]
    v_mfma_f32_16x16x32_bf16 v[52:55], a[168:171], v[240:243], v[52:55]
    v_mfma_f32_16x16x32_bf16 v[56:59], a[172:175], v[240:243], v[56:59]
    s_nop 4
    v_add_f32 v44, v44, v64
    v_add_f32 v45, v45, v65
    v_mfma_f32_16x16x32_bf16 v[52:55], a[188:191], v[244:247], v[52:55]
    v_add_f32 v46, v46, v66
    v_add_f32 v47, v47, v67
    v_mfma_f32_16x16x32_bf16 v[56:59], a[192:195], v[244:247], v[56:59]
    v_add_f32 v48, v48, v68
    v_add_f32 v49, v49, v69
    v_mfma_f32_16x16x32_bf16 v[52:55], a[208:211], v[248:251], v[52:55]
    v_add_f32 v50, v50, v70
    v_add_f32 v51, v51, v71
    v_mfma_f32_16x16x32_bf16 v[56:59], a[212:215], v[248:251], v[56:59]
    v_cvt_pk_bf16_f32 v128, v44, v45
    v_cvt_pk_bf16_f32 v129, v46, v47
    v_mfma_f32_16x16x32_bf16 v[52:55], a[228:231], v[252:255], v[52:55]
    v_cvt_pk_bf16_f32 v130, v48, v49
    v_cvt_pk_bf16_f32 v131, v50, v51
    v_mfma_f32_16x16x32_bf16 v[56:59], a[232:235], v[252:255], v[56:59]
    v_permlane32_swap_b32 v128, v130
    v_permlane32_swap_b32 v129, v131
    v_mfma_f32_16x16x32_bf16 v[60:63], v[224:227], a[96:99], v[60:63]
    ds_bpermute_b32 v144, v2, v128
    ds_bpermute_b32 v146, v2, v130
    v_mfma_f32_16x16x32_bf16 v[60:63], v[228:231], a[116:119], v[60:63]
    ds_bpermute_b32 v145, v2, v129
    ds_bpermute_b32 v147, v2, v131
    v_mfma_f32_16x16x32_bf16 v[60:63], v[232:235], a[136:139], v[60:63]
    v_cvt_pk_bf16_f32 v132, v52, v53
    v_cvt_pk_bf16_f32 v133, v54, v55
    v_mfma_f32_16x16x32_bf16 v[60:63], v[236:239], a[156:159], v[60:63]
    v_cvt_pk_bf16_f32 v134, v56, v57
    v_cvt_pk_bf16_f32 v135, v58, v59
    v_mfma_f32_16x16x32_bf16 v[60:63], v[240:243], a[176:179], v[60:63]
    v_permlane32_swap_b32 v132, v134
    v_permlane32_swap_b32 v133, v135
    v_mfma_f32_16x16x32_bf16 v[60:63], v[244:247], a[196:199], v[60:63]
    ds_bpermute_b32 v148, v2, v132
    ds_bpermute_b32 v150, v2, v134
    v_mfma_f32_16x16x32_bf16 v[60:63], v[248:251], a[216:219], v[60:63]
    ds_bpermute_b32 v149, v2, v133
    ds_bpermute_b32 v151, v2, v135
    v_mfma_f32_16x16x32_bf16 v[60:63], v[252:255], a[236:239], v[60:63]
    s_waitcnt lgkmcnt(4)
    buffer_store_dwordx4 v[144:147], v3, s[28:31], s3 offen offset:0
    s_nop 5
    v_cvt_pk_bf16_f32 v136, v60, v61
    v_cvt_pk_bf16_f32 v137, v62, v63
    buffer_store_short v136, v4, s[28:31], s7 offen offset:128
    buffer_store_short_d16_hi v136, v4, s[28:31], s7 offen offset:1408
    buffer_store_short v137, v4, s[28:31], s7 offen offset:2688
    buffer_store_short_d16_hi v137, v4, s[28:31], s7 offen offset:3968
    s_waitcnt lgkmcnt(0)
    buffer_store_dwordx4 v[148:151], v3, s[28:31], s3 offen offset:64
    s_or_b32 s45, s36, s2
    s_cmp_lg_u32 s45, 0
    s_cbranch_scc1 L_nobump
    s_add_u32 s47, s47, 1
    v_mov_b32 v17, s47
    s_mov_b32 s45, 6324224
    s_mov_b64 exec, 1
    buffer_store_dword v17, off, s[32:35], s45
    s_mov_b64 exec, -1
L_nobump:
L_end:
s_endpgm
.section .rodata,"a"
.p2align 6
.amdhsa_kernel standalone__dense_activation_silu__prompt_kernel
  .amdhsa_next_free_vgpr 512
  .amdhsa_next_free_sgpr 102
  .amdhsa_accum_offset 256
  .amdhsa_group_segment_fixed_size 0
  .amdhsa_kernarg_size 48
  .amdhsa_user_sgpr_count 2
  .amdhsa_user_sgpr_kernarg_segment_ptr 1
  .amdhsa_system_sgpr_workgroup_id_x 1
.end_amdhsa_kernel
```
